```python
import torch

def _softmax(x, axis=-1):
    return torch.softmax(x, dim=axis)
def _gelu(x):
    return torch.nn.functional.gelu(x, approximate="tanh")
def _silu(x):
    return torch.nn.functional.silu(x)
def _sigmoid(x):
    return torch.sigmoid(x)
def _layernorm(x, axis=-1, eps=1e-5):
    m = x.mean(dim=axis, keepdim=True)
    v = x.var(dim=axis, keepdim=True, unbiased=False)
    return (x - m) / torch.sqrt(v + eps)
def _scatter_add(tgt, idx, src, axis=0):
    return tgt.clone().index_add_(axis, idx, src)
def _segment_sum(src, seg, n):
    out = torch.zeros((n,) + src.shape[1:], dtype=src.dtype)
    return out.index_add_(0, seg, src)
def _pad(x, pw):
    flat = tuple(v for pair in reversed(pw) for v in pair)
    return torch.nn.functional.pad(x, flat)

kernel_name = 'gated_mix__sliding_block_cached__glu_gated_swiglu__decode'

def setup_inputs():

    _w = (lambda a: (lambda t: t.to(torch.bfloat16) if t.is_floating_point() else t)(torch.as_tensor(a)))
    def _A_setup():
        B, Sq, D = 8, 1, 512
        Hq, Hkv, Sk, Dh = 32, 32, 4096, 128
        assert Hq % Hkv == 0, (Hq, Hkv)
        return {
            "x": _w((lambda *s: torch.randn(*s, dtype=torch.bfloat16) * 0.05)(B, Sq, D)),
            "k_cache": _w((lambda *s: torch.randn(*s, dtype=torch.bfloat16) * 3.2)(B, Hkv, Sk, Dh)),
            "v_cache": _w((lambda *s: torch.randn(*s, dtype=torch.bfloat16) * 0.05)(B, Hkv, Sk, Dh)),
            "wq": _w((lambda *s: torch.randn(*s, dtype=torch.bfloat16) * 3.2)(D, Hq * Dh) * (D ** -0.5)),
            "wo": _w((lambda *s: torch.randn(*s, dtype=torch.bfloat16) * 0.05)(Hq * Dh, D) * ((Hq * Dh) ** -0.5)),
        }
    _A_in = _A_setup()

    def _B_setup():
        B, S, D, F = 8, 1, 512, 1376
        return {
            "x": _w((lambda *s: torch.randn(*s, dtype=torch.bfloat16) * 0.05)(B, S, D)),
            "w1": _w((lambda *s: torch.randn(*s, dtype=torch.bfloat16) * 0.2)(D, F) * (2.0 / D) ** 0.5),
            "w3": _w((lambda *s: torch.randn(*s, dtype=torch.bfloat16) * 0.2)(D, F) * (2.0 / D) ** 0.5),
            "w2": _w((lambda *s: torch.randn(*s, dtype=torch.bfloat16) * 0.2)(F, D) * (2.0 / F) ** 0.5),
        }
    _B_in = _B_setup()

    return {
        "A_x": _A_in["x"],
        "A_k_cache": _A_in["k_cache"],
        "A_v_cache": _A_in["v_cache"],
        "A_wq": _A_in["wq"],
        "A_wo": _A_in["wo"],
        "B_x": _B_in["x"],
        "B_w1": _B_in["w1"],
        "B_w3": _B_in["w3"],
        "B_w2": _B_in["w2"],
        "gate_w": _w((lambda *s: torch.randn(*s, dtype=torch.bfloat16) * 0.05)(512) * 16.0),
    }

def reference(A_x, A_k_cache, A_v_cache, A_wq, A_wo, B_x, B_w1, B_w3, B_w2, gate_w):
    def _A_ref(x, k_cache, v_cache, wq, wo):
        B, Sq, D = x.shape
        Hq, Dh = 32, 128
        Hkv, Sk = k_cache.shape[1], k_cache.shape[2]
        W = min(4096, max(256, Sk // 4))
        rep = Hq // Hkv
        q = (lambda x, *d: x.permute(*d))((x @ wq).reshape(B, Sq, Hq, Dh), 0, 2, 1, 3)
        k = (lambda x, n, axis: torch.repeat_interleave(x, n, dim=axis))(k_cache[:, :, Sk - W:, :], rep, axis=1)
        v = (lambda x, n, axis: torch.repeat_interleave(x, n, dim=axis))(v_cache[:, :, Sk - W:, :], rep, axis=1)
        scores = torch.einsum("bhqd,bhkd->bhqk", q, k) * (Dh ** -0.5)
        p = _softmax(scores, axis=-1)
        o = torch.einsum("bhqk,bhkd->bhqd", p, v)
        return (lambda x, *d: x.permute(*d))(o, 0, 2, 1, 3).reshape(B, Sq, Hq * Dh) @ wo

    def _B_ref(x, w1, w3, w2):
        gate = torch.einsum("bsd,df->bsf", x, w1)
        up = torch.einsum("bsd,df->bsf", x, w3)
        h = _silu(gate) * up
        out = torch.einsum("bsf,fd->bsd", h, w2)
        return out

    x = A_x
    g = _sigmoid((x * gate_w).sum(-1, keepdims=True))
    a = _A_ref(x, A_k_cache, A_v_cache, A_wq, A_wo)
    b = _B_ref(x, B_w1, B_w3, B_w2)
    return g * a + (1 - g) * b
```

```asm
; @launch grid=(256,1,1) block=(512,1,1) lds=40960
.amdgcn_target "amdgcn-amd-amdhsa--gfx950"
.text
.globl gated_mix__sliding_block_cached__glu_gated_swiglu__decode_kernel
.p2align 8
.type gated_mix__sliding_block_cached__glu_gated_swiglu__decode_kernel,@function
gated_mix__sliding_block_cached__glu_gated_swiglu__decode_kernel:
  s_load_dwordx16 s[4:19], s[0:1], 0
  v_readfirstlane_b32 s3, v0
  s_lshr_b32 s74, s2, 8
  s_cbranch_scc1 L_end
  s_bitcmp1_b32 s3, 8
  s_cbranch_scc1 L_wrole
  v_and_b32 v48, 3, v0
  v_and_b32 v49, 48, v0
  v_lshlrev_b32 v48, 4, v48
  v_lshl_or_b32 v48, v49, 2, v48
  v_and_b32 v49, 4, v0
  v_and_b32 v50, 8, v0
  v_lshl_or_b32 v48, v49, 6, v48
  v_lshl_or_b32 v3, v50, 10, v48
  s_lshl_b32 s83, s3, 4
  s_lshl_b32 s74, s2, 20
  s_add_u32 s74, s74, 0xC0000
  s_bfm_b32 s34, 1, 18
  s_mov_b32 s35, 0x20000
  s_waitcnt lgkmcnt(0)
  s_add_u32 s32, s6, s74
  s_addc_u32 s33, s7, 0
  buffer_load_dwordx4 v[56:59], v3, s[32:35], s83 offen offset:0 nt
  buffer_load_dwordx4 v[60:63], v3, s[32:35], s83 offen offset:512 nt
  s_xor_b32 s68, s83, 32768
  buffer_load_dwordx4 v[64:67], v3, s[32:35], s68 offen offset:0 nt
  buffer_load_dwordx4 v[68:71], v3, s[32:35], s68 offen offset:512 nt
  s_load_dwordx8 s[20:27], s[0:1], 64
  s_load_dwordx2 s[28:29], s[0:1], 96
  v_lshlrev_b32 v2, 4, v0
  v_mov_b32 v4, -1
  v_mov_b32 v5, -1
  v_mov_b32 v6, -1
  v_mov_b32 v7, -1
  ds_write_b128 v2, v[4:7]
  v_and_b32 v0, 63, v0
  v_lshlrev_b32 v1, 4, v0
  s_lshr_b32 s3, s3, 6
  s_and_b32 s30, s2, 31
  s_lshr_b32 s31, s2, 5
  s_mov_b32 s79, 2097152
  s_xor_b32 s68, s83, 65536
  buffer_load_dwordx4 v[72:75], v3, s[32:35], s68 offen offset:0 nt
  s_and_b32 s72, s30, 7
  s_mul_i32 s72, s72, 43
  s_add_u32 s73, s72, 43
  s_lshr_b32 s72, s72, 3
  s_lshr_b32 s73, s73, 3
  s_sub_u32 s73, s73, s72
  s_lshl_b32 s72, s72, 2
  s_lshr_b32 s75, s30, 3
  s_mul_i32 s75, s75, s73
  s_add_u32 s72, s72, s75
  s_and_b32 s76, s31, 1
  s_lshl_b32 s75, s30, 1
  s_add_u32 s75, s75, s76
  s_lshl_b32 s75, s75, 7
  s_add_u32 s48, s10, s75
  s_addc_u32 s49, s11, 0
  s_sub_u32 s50, 0x400000, s75
  s_mov_b32 s51, 0x20000
  s_cmp_eq_u32 s76, 0
  s_cselect_b64 s[16:17], s[16:17], s[18:19]
  s_lshl_b32 s75, s72, 4
  s_add_u32 s40, s16, s75
  s_addc_u32 s41, s17, 0
  s_sub_u32 s42, 1409024, s75
  s_mov_b32 s43, 0x20000
  s_lshr_b32 s75, s31, 1
  s_lshl_b32 s75, s75, 2
  s_add_u32 s75, s75, s3
  s_lshl_b32 s80, s75, 18
  s_mul_i32 s81, s75, 88064
  s_lshl_b32 s75, s3, 12
  s_add_u32 m0, s75, 8192
  v_lshrrev_b32 v48, 3, v0
  v_and_b32 v49, 7, v0
  v_lshlrev_b32 v50, 4, v49
  v_lshl_or_b32 v12, v48, 13, v50
  v_mul_u32_u24 v13, 2752, v48
  v_add_u32 v13, v13, v50
  v_cmp_gt_u32 vcc, s73, v49
  v_mov_b32 v50, 0x40000000
  s_nop 0
  v_cndmask_b32 v13, v50, v13, vcc
  s_lshl_b32 s75, s3, 2
  v_mov_b32 v14, s75
  s_waitcnt lgkmcnt(0)
  s_load_dwordx2 s[84:85], s[28:29], 0
  s_movk_i32 s96, 6
L_w5:
  s_getreg_b32 s97, hwreg(HW_REG_IB_STS, 0, 4)
  s_cmp_lt_u32 s97, 5
  s_cbranch_scc1 L_g5
  s_sub_u32 s96, s96, 1
  s_cbranch_scc0 L_w5
L_g5:
  buffer_load_dwordx4 v12, s[48:51], s80 offen nt lds
  s_movk_i32 s96, 6
L_w6:
  s_getreg_b32 s97, hwreg(HW_REG_IB_STS, 0, 4)
  s_cmp_lt_u32 s97, 5
  s_cbranch_scc1 L_g6
  s_sub_u32 s96, s96, 1
  s_cbranch_scc0 L_w6
L_g6:
  s_addk_i32 m0, 1024
  s_add_u32 s80, s80, 65536
  buffer_load_dwordx4 v12, s[48:51], s80 offen nt lds
  s_add_u32 s36, s8, s74
  s_addc_u32 s37, s9, 0
  s_mov_b32 s38, 262144
  s_mov_b32 s39, 0x20000
  s_mov_b32 s60, s28
  s_mov_b32 s61, s29
  s_mov_b32 s62, 2097152
  s_mov_b32 s63, 0x20000
  v_and_b32 v48, 15, v0
  v_lshlrev_b32 v48, 4, v48
  v_and_b32 v49, 16, v0
  v_and_b32 v50, 32, v0
  v_lshl_or_b32 v48, v49, 4, v48
  v_lshl_or_b32 v6, v50, 8, v48
  v_and_b32 v48, 1, v0
  v_lshlrev_b32 v48, 4, v48
  v_bfe_u32 v50, v0, 1, 4
  v_or_b32 v50, v50, v48
  v_lshlrev_b32 v5, 4, v50
  v_mov_b32 v49, 0xffff
  v_lshlrev_b32 v48, v48, v49
  v_bfe_u32 v49, v0, 1, 2
  v_cmp_eq_u32 vcc, 0, v49
  s_nop 1
  v_cndmask_b32 v8, 0, v48, vcc
  v_cmp_eq_u32 vcc, 1, v49
  s_nop 1
  v_cndmask_b32 v9, 0, v48, vcc
  v_cmp_eq_u32 vcc, 2, v49
  s_nop 1
  v_cndmask_b32 v10, 0, v48, vcc
  v_cmp_eq_u32 vcc, 3, v49
  s_nop 1
  v_cndmask_b32 v11, 0, v48, vcc
  s_lshl_b32 s75, s3, 9
  v_add_u32 v4, s75, v1
  s_lshl_b32 s70, s30, 12
  s_lshl_b32 s75, s31, 9
  s_add_u32 s70, s70, s75
  s_add_u32 s71, s70, 0x40000
  s_add_u32 s70, s70, 0x20000
  s_movk_i32 s96, 6
L_w7:
  s_getreg_b32 s97, hwreg(HW_REG_IB_STS, 0, 4)
  s_cmp_lt_u32 s97, 5
  s_cbranch_scc1 L_g7
  s_sub_u32 s96, s96, 1
  s_cbranch_scc0 L_w7
L_g7:
  s_waitcnt vmcnt(6)
  s_addk_i32 m0, 1024
  s_add_u32 s80, s80, 65536
  buffer_load_dwordx4 v12, s[48:51], s80 offen nt lds
  s_movk_i32 s96, 6
L_w8:
  s_getreg_b32 s97, hwreg(HW_REG_IB_STS, 0, 4)
  s_cmp_lt_u32 s97, 5
  s_cbranch_scc1 L_g8
  s_sub_u32 s96, s96, 1
  s_cbranch_scc0 L_w8
L_g8:
  s_waitcnt vmcnt(6)
  s_addk_i32 m0, 1024
  s_add_u32 s80, s80, 65536
  buffer_load_dwordx4 v12, s[48:51], s80 offen nt lds
  s_movk_i32 s96, 6
L_w9:
  s_getreg_b32 s97, hwreg(HW_REG_IB_STS, 0, 4)
  s_cmp_lt_u32 s97, 5
  s_cbranch_scc1 L_g9
  s_sub_u32 s96, s96, 1
  s_cbranch_scc0 L_w9
L_g9:
  s_waitcnt vmcnt(6)
  s_add_u32 m0, m0, 13312
  s_nop 0
  buffer_load_dwordx4 v13, s[40:43], s81 offen nt lds
  s_movk_i32 s96, 6
L_w10:
  s_getreg_b32 s97, hwreg(HW_REG_IB_STS, 0, 4)
  s_cmp_lt_u32 s97, 5
  s_cbranch_scc1 L_g10
  s_sub_u32 s96, s96, 1
  s_cbranch_scc0 L_w10
L_g10:
  s_waitcnt vmcnt(6)
  s_addk_i32 m0, 1024
  s_add_u32 s81, s81, 22016
  buffer_load_dwordx4 v13, s[40:43], s81 offen nt lds
  s_movk_i32 s96, 6
L_w11:
  s_getreg_b32 s97, hwreg(HW_REG_IB_STS, 0, 4)
  s_cmp_lt_u32 s97, 5
  s_cbranch_scc1 L_g11
  s_sub_u32 s96, s96, 1
  s_cbranch_scc0 L_w11
L_g11:
  s_waitcnt vmcnt(6)
  s_addk_i32 m0, 1024
  s_add_u32 s81, s81, 22016
  buffer_load_dwordx4 v13, s[40:43], s81 offen nt lds
  s_movk_i32 s96, 6
L_w12:
  s_getreg_b32 s97, hwreg(HW_REG_IB_STS, 0, 4)
  s_cmp_lt_u32 s97, 5
  s_cbranch_scc1 L_g12
  s_sub_u32 s96, s96, 1
  s_cbranch_scc0 L_w12
L_g12:
  s_waitcnt vmcnt(6)
  s_addk_i32 m0, 1024
  s_add_u32 s81, s81, 22016
  buffer_load_dwordx4 v13, s[40:43], s81 offen nt lds
  s_movk_i32 s96, 6
L_w13:
  s_getreg_b32 s97, hwreg(HW_REG_IB_STS, 0, 4)
  s_cmp_lt_u32 s97, 5
  s_cbranch_scc1 L_g13
  s_sub_u32 s96, s96, 1
  s_cbranch_scc0 L_w13
L_g13:
  s_waitcnt vmcnt(6)
  buffer_load_dwordx4 v[76:79], v3, s[32:35], s68 offen offset:512 nt
  s_movk_i32 s96, 6
L_w14:
  s_getreg_b32 s97, hwreg(HW_REG_IB_STS, 0, 4)
  s_cmp_lt_u32 s97, 5
  s_cbranch_scc1 L_g14
  s_sub_u32 s96, s96, 1
  s_cbranch_scc0 L_w14
L_g14:
  s_waitcnt vmcnt(6)
  s_xor_b32 s68, s83, 98304
  buffer_load_dwordx4 v[80:83], v3, s[32:35], s68 offen offset:0 nt
  s_waitcnt lgkmcnt(0)
  s_barrier
  s_add_u32 s84, s84, 0x7f4a7c15
  s_addc_u32 s85, s85, 0x9e3779b9
  s_movk_i32 s96, 6
L_w15:
  s_getreg_b32 s97, hwreg(HW_REG_IB_STS, 0, 4)
  s_cmp_lt_u32 s97, 5
  s_cbranch_scc1 L_g15
  s_sub_u32 s96, s96, 1
  s_cbranch_scc0 L_w15
L_g15:
  s_waitcnt vmcnt(6)
  buffer_load_dwordx4 v[84:87], v3, s[32:35], s68 offen offset:512 nt
  ds_write_b32 v14, v14 offset:368
  s_movk_i32 s96, 6
L_w16:
  s_getreg_b32 s97, hwreg(HW_REG_IB_STS, 0, 4)
  s_cmp_lt_u32 s97, 5
  s_cbranch_scc1 L_g16
  s_sub_u32 s96, s96, 1
  s_cbranch_scc0 L_w16
L_g16:
  s_waitcnt vmcnt(6)
  s_xor_b32 s68, s83, 16384
  buffer_load_dwordx4 v[88:91], v3, s[32:35], s68 offen offset:0 nt
  s_movk_i32 s96, 6
L_w17:
  s_getreg_b32 s97, hwreg(HW_REG_IB_STS, 0, 4)
  s_cmp_lt_u32 s97, 5
  s_cbranch_scc1 L_g17
  s_sub_u32 s96, s96, 1
  s_cbranch_scc0 L_w17
L_g17:
  s_waitcnt vmcnt(6)
  buffer_load_dwordx4 v[92:95], v3, s[32:35], s68 offen offset:512 nt
  s_movk_i32 s96, 6
L_w18:
  s_getreg_b32 s97, hwreg(HW_REG_IB_STS, 0, 4)
  s_cmp_lt_u32 s97, 5
  s_cbranch_scc1 L_g18
  s_sub_u32 s96, s96, 1
  s_cbranch_scc0 L_w18
L_g18:
  s_waitcnt vmcnt(6)
  s_xor_b32 s68, s83, 49152
  buffer_load_dwordx4 v[96:99], v3, s[32:35], s68 offen offset:0 nt
  s_movk_i32 s96, 6
L_w19:
  s_getreg_b32 s97, hwreg(HW_REG_IB_STS, 0, 4)
  s_cmp_lt_u32 s97, 5
  s_cbranch_scc1 L_g19
  s_sub_u32 s96, s96, 1
  s_cbranch_scc0 L_w19
L_g19:
  s_waitcnt vmcnt(6)
  buffer_load_dwordx4 v[100:103], v3, s[32:35], s68 offen offset:512 nt
  ds_write_b32 v14, v14 offset:384
  s_movk_i32 s96, 6
L_w20:
  s_getreg_b32 s97, hwreg(HW_REG_IB_STS, 0, 4)
  s_cmp_lt_u32 s97, 5
  s_cbranch_scc1 L_g20
  s_sub_u32 s96, s96, 1
  s_cbranch_scc0 L_w20
L_g20:
  s_waitcnt vmcnt(6)
  s_xor_b32 s68, s83, 81920
  buffer_load_dwordx4 v[104:107], v3, s[32:35], s68 offen offset:0 nt
  s_movk_i32 s96, 6
L_w21:
  s_getreg_b32 s97, hwreg(HW_REG_IB_STS, 0, 4)
  s_cmp_lt_u32 s97, 5
  s_cbranch_scc1 L_g21
  s_sub_u32 s96, s96, 1
  s_cbranch_scc0 L_w21
L_g21:
  s_waitcnt vmcnt(6)
  buffer_load_dwordx4 v[108:111], v3, s[32:35], s68 offen offset:512 nt
  s_movk_i32 s96, 6
L_w22:
  s_getreg_b32 s97, hwreg(HW_REG_IB_STS, 0, 4)
  s_cmp_lt_u32 s97, 5
  s_cbranch_scc1 L_g22
  s_sub_u32 s96, s96, 1
  s_cbranch_scc0 L_w22
L_g22:
  s_waitcnt vmcnt(6)
  s_xor_b32 s68, s83, 114688
  buffer_load_dwordx4 v[112:115], v3, s[32:35], s68 offen offset:0 nt
  s_movk_i32 s96, 6
L_w23:
  s_getreg_b32 s97, hwreg(HW_REG_IB_STS, 0, 4)
  s_cmp_lt_u32 s97, 5
  s_cbranch_scc1 L_g23
  s_sub_u32 s96, s96, 1
  s_cbranch_scc0 L_w23
L_g23:
  s_waitcnt vmcnt(6)
  buffer_load_dwordx4 v[116:119], v3, s[32:35], s68 offen offset:512 nt
  s_movk_i32 s96, 6
L_w24:
  s_getreg_b32 s97, hwreg(HW_REG_IB_STS, 0, 4)
  s_cmp_lt_u32 s97, 5
  s_cbranch_scc1 L_g24
  s_sub_u32 s96, s96, 1
  s_cbranch_scc0 L_w24
L_g24:
  s_waitcnt vmcnt(6)
  s_xor_b32 s68, s83, 4096
  buffer_load_dwordx4 v[120:123], v3, s[32:35], s68 offen offset:0 nt
  s_movk_i32 s96, 6
L_w25:
  s_getreg_b32 s97, hwreg(HW_REG_IB_STS, 0, 4)
  s_cmp_lt_u32 s97, 5
  s_cbranch_scc1 L_g25
  s_sub_u32 s96, s96, 1
  s_cbranch_scc0 L_w25
L_g25:
  s_waitcnt vmcnt(6)
  buffer_load_dwordx4 v[124:127], v3, s[32:35], s68 offen offset:512 nt
  s_movk_i32 s96, 6
L_w26:
  s_getreg_b32 s97, hwreg(HW_REG_IB_STS, 0, 4)
  s_cmp_lt_u32 s97, 5
  s_cbranch_scc1 L_g26
  s_sub_u32 s96, s96, 1
  s_cbranch_scc0 L_w26
L_g26:
  s_waitcnt vmcnt(6)
  s_xor_b32 s68, s83, 36864
  buffer_load_dwordx4 v[128:131], v3, s[32:35], s68 offen offset:0 nt
  s_movk_i32 s96, 6
L_w27:
  s_getreg_b32 s97, hwreg(HW_REG_IB_STS, 0, 4)
  s_cmp_lt_u32 s97, 5
  s_cbranch_scc1 L_g27
  s_sub_u32 s96, s96, 1
  s_cbranch_scc0 L_w27
L_g27:
  s_waitcnt vmcnt(6)
  buffer_load_dwordx4 v[132:135], v3, s[32:35], s68 offen offset:512 nt
  s_movk_i32 s96, 6
L_w28:
  s_getreg_b32 s97, hwreg(HW_REG_IB_STS, 0, 4)
  s_cmp_lt_u32 s97, 5
  s_cbranch_scc1 L_g28
  s_sub_u32 s96, s96, 1
  s_cbranch_scc0 L_w28
L_g28:
  s_waitcnt vmcnt(6)
  s_xor_b32 s68, s83, 69632
  buffer_load_dwordx4 v[136:139], v3, s[32:35], s68 offen offset:0 nt
  s_movk_i32 s96, 6
L_w29:
  s_getreg_b32 s97, hwreg(HW_REG_IB_STS, 0, 4)
  s_cmp_lt_u32 s97, 5
  s_cbranch_scc1 L_g29
  s_sub_u32 s96, s96, 1
  s_cbranch_scc0 L_w29
L_g29:
  s_waitcnt vmcnt(6)
  buffer_load_dwordx4 v[140:143], v3, s[32:35], s68 offen offset:512 nt
  s_movk_i32 s96, 6
L_w30:
  s_getreg_b32 s97, hwreg(HW_REG_IB_STS, 0, 4)
  s_cmp_lt_u32 s97, 5
  s_cbranch_scc1 L_g30
  s_sub_u32 s96, s96, 1
  s_cbranch_scc0 L_w30
L_g30:
  s_waitcnt vmcnt(6)
  s_xor_b32 s68, s83, 102400
  buffer_load_dwordx4 v[144:147], v3, s[32:35], s68 offen offset:0 nt
  s_movk_i32 s96, 6
L_w31:
  s_getreg_b32 s97, hwreg(HW_REG_IB_STS, 0, 4)
  s_cmp_lt_u32 s97, 5
  s_cbranch_scc1 L_g31
  s_sub_u32 s96, s96, 1
  s_cbranch_scc0 L_w31
L_g31:
  s_waitcnt vmcnt(6)
  buffer_load_dwordx4 v[148:151], v3, s[32:35], s68 offen offset:512 nt
  s_movk_i32 s96, 6
L_w32:
  s_getreg_b32 s97, hwreg(HW_REG_IB_STS, 0, 4)
  s_cmp_lt_u32 s97, 5
  s_cbranch_scc1 L_g32
  s_sub_u32 s96, s96, 1
  s_cbranch_scc0 L_w32
L_g32:
  s_waitcnt vmcnt(6)
  s_xor_b32 s68, s83, 20480
  buffer_load_dwordx4 v[152:155], v3, s[32:35], s68 offen offset:0 nt
  s_movk_i32 s96, 6
L_w33:
  s_getreg_b32 s97, hwreg(HW_REG_IB_STS, 0, 4)
  s_cmp_lt_u32 s97, 5
  s_cbranch_scc1 L_g33
  s_sub_u32 s96, s96, 1
  s_cbranch_scc0 L_w33
L_g33:
  s_waitcnt vmcnt(6)
  buffer_load_dwordx4 v[156:159], v3, s[32:35], s68 offen offset:512 nt
  s_movk_i32 s96, 6
L_w34:
  s_getreg_b32 s97, hwreg(HW_REG_IB_STS, 0, 4)
  s_cmp_lt_u32 s97, 5
  s_cbranch_scc1 L_g34
  s_sub_u32 s96, s96, 1
  s_cbranch_scc0 L_w34
L_g34:
  s_waitcnt vmcnt(6)
  s_xor_b32 s68, s83, 53248
  buffer_load_dwordx4 v[160:163], v3, s[32:35], s68 offen offset:0 nt
  s_movk_i32 s96, 6
L_w35:
  s_getreg_b32 s97, hwreg(HW_REG_IB_STS, 0, 4)
  s_cmp_lt_u32 s97, 5
  s_cbranch_scc1 L_g35
  s_sub_u32 s96, s96, 1
  s_cbranch_scc0 L_w35
L_g35:
  s_waitcnt vmcnt(6)
  buffer_load_dwordx4 v[164:167], v3, s[32:35], s68 offen offset:512 nt
  s_movk_i32 s96, 6
L_w36:
  s_getreg_b32 s97, hwreg(HW_REG_IB_STS, 0, 4)
  s_cmp_lt_u32 s97, 5
  s_cbranch_scc1 L_g36
  s_sub_u32 s96, s96, 1
  s_cbranch_scc0 L_w36
L_g36:
  s_waitcnt vmcnt(6)
  s_xor_b32 s68, s83, 86016
  buffer_load_dwordx4 v[168:171], v3, s[32:35], s68 offen offset:0 nt
  s_movk_i32 s96, 6
L_w37:
  s_getreg_b32 s97, hwreg(HW_REG_IB_STS, 0, 4)
  s_cmp_lt_u32 s97, 5
  s_cbranch_scc1 L_g37
  s_sub_u32 s96, s96, 1
  s_cbranch_scc0 L_w37
L_g37:
  s_waitcnt vmcnt(6)
  buffer_load_dwordx4 v[172:175], v3, s[32:35], s68 offen offset:512 nt
  s_movk_i32 s96, 6
L_w38:
  s_getreg_b32 s97, hwreg(HW_REG_IB_STS, 0, 4)
  s_cmp_lt_u32 s97, 5
  s_cbranch_scc1 L_g38
  s_sub_u32 s96, s96, 1
  s_cbranch_scc0 L_w38
L_g38:
  s_waitcnt vmcnt(6)
  s_xor_b32 s68, s83, 118784
  buffer_load_dwordx4 v[176:179], v3, s[32:35], s68 offen offset:0 nt
  s_movk_i32 s96, 6
L_w39:
  s_getreg_b32 s97, hwreg(HW_REG_IB_STS, 0, 4)
  s_cmp_lt_u32 s97, 5
  s_cbranch_scc1 L_g39
  s_sub_u32 s96, s96, 1
  s_cbranch_scc0 L_w39
L_g39:
  s_waitcnt vmcnt(6)
  buffer_load_dwordx4 v[180:183], v3, s[32:35], s68 offen offset:512 nt
  s_movk_i32 s96, 6
L_w40:
  s_getreg_b32 s97, hwreg(HW_REG_IB_STS, 0, 4)
  s_cmp_lt_u32 s97, 5
  s_cbranch_scc1 L_g40
  s_sub_u32 s96, s96, 1
  s_cbranch_scc0 L_w40
L_g40:
  s_waitcnt vmcnt(6)
  s_xor_b32 s68, s83, 131072
  buffer_load_dwordx4 v[184:187], v3, s[32:35], s68 offen offset:0 nt
  s_movk_i32 s96, 6
L_w41:
  s_getreg_b32 s97, hwreg(HW_REG_IB_STS, 0, 4)
  s_cmp_lt_u32 s97, 5
  s_cbranch_scc1 L_g41
  s_sub_u32 s96, s96, 1
  s_cbranch_scc0 L_w41
L_g41:
  s_waitcnt vmcnt(6)
  buffer_load_dwordx4 v[188:191], v3, s[32:35], s68 offen offset:512 nt
  s_movk_i32 s96, 6
L_w42:
  s_getreg_b32 s97, hwreg(HW_REG_IB_STS, 0, 4)
  s_cmp_lt_u32 s97, 5
  s_cbranch_scc1 L_g42
  s_sub_u32 s96, s96, 1
  s_cbranch_scc0 L_w42
L_g42:
  s_waitcnt vmcnt(6)
  s_xor_b32 s68, s83, 163840
  buffer_load_dwordx4 v[192:195], v3, s[32:35], s68 offen offset:0 nt
  s_movk_i32 s96, 6
L_w43:
  s_getreg_b32 s97, hwreg(HW_REG_IB_STS, 0, 4)
  s_cmp_lt_u32 s97, 5
  s_cbranch_scc1 L_g43
  s_sub_u32 s96, s96, 1
  s_cbranch_scc0 L_w43
L_g43:
  s_waitcnt vmcnt(6)
  buffer_load_dwordx4 v[196:199], v3, s[32:35], s68 offen offset:512 nt
  s_movk_i32 s96, 6
L_w44:
  s_getreg_b32 s97, hwreg(HW_REG_IB_STS, 0, 4)
  s_cmp_lt_u32 s97, 5
  s_cbranch_scc1 L_g44
  s_sub_u32 s96, s96, 1
  s_cbranch_scc0 L_w44
L_g44:
  s_waitcnt vmcnt(6)
  s_xor_b32 s68, s83, 196608
  buffer_load_dwordx4 v[200:203], v3, s[32:35], s68 offen offset:0 nt
  s_movk_i32 s96, 6
L_w45:
  s_getreg_b32 s97, hwreg(HW_REG_IB_STS, 0, 4)
  s_cmp_lt_u32 s97, 5
  s_cbranch_scc1 L_g45
  s_sub_u32 s96, s96, 1
  s_cbranch_scc0 L_w45
L_g45:
  s_waitcnt vmcnt(6)
  buffer_load_dwordx4 v[204:207], v3, s[32:35], s68 offen offset:512 nt
  s_movk_i32 s96, 6
L_w46:
  s_getreg_b32 s97, hwreg(HW_REG_IB_STS, 0, 4)
  s_cmp_lt_u32 s97, 5
  s_cbranch_scc1 L_g46
  s_sub_u32 s96, s96, 1
  s_cbranch_scc0 L_w46
L_g46:
  s_waitcnt vmcnt(6)
  s_xor_b32 s68, s83, 229376
  buffer_load_dwordx4 v[208:211], v3, s[32:35], s68 offen offset:0 nt
  s_movk_i32 s96, 6
L_w47:
  s_getreg_b32 s97, hwreg(HW_REG_IB_STS, 0, 4)
  s_cmp_lt_u32 s97, 5
  s_cbranch_scc1 L_g47
  s_sub_u32 s96, s96, 1
  s_cbranch_scc0 L_w47
L_g47:
  s_waitcnt vmcnt(6)
  buffer_load_dwordx4 v[212:215], v3, s[32:35], s68 offen offset:512 nt
  s_movk_i32 s96, 6
L_w48:
  s_getreg_b32 s97, hwreg(HW_REG_IB_STS, 0, 4)
  s_cmp_lt_u32 s97, 5
  s_cbranch_scc1 L_g48
  s_sub_u32 s96, s96, 1
  s_cbranch_scc0 L_w48
L_g48:
  s_waitcnt vmcnt(6)
  s_xor_b32 s68, s83, 147456
  buffer_load_dwordx4 v[216:219], v3, s[32:35], s68 offen offset:0 nt
  s_movk_i32 s96, 6
L_w49:
  s_getreg_b32 s97, hwreg(HW_REG_IB_STS, 0, 4)
  s_cmp_lt_u32 s97, 5
  s_cbranch_scc1 L_g49
  s_sub_u32 s96, s96, 1
  s_cbranch_scc0 L_w49
L_g49:
  s_waitcnt vmcnt(6)
  buffer_load_dwordx4 v[220:223], v3, s[32:35], s68 offen offset:512 nt
  s_movk_i32 s96, 6
L_w50:
  s_getreg_b32 s97, hwreg(HW_REG_IB_STS, 0, 4)
  s_cmp_lt_u32 s97, 5
  s_cbranch_scc1 L_g50
  s_sub_u32 s96, s96, 1
  s_cbranch_scc0 L_w50
L_g50:
  s_waitcnt vmcnt(6)
  s_xor_b32 s68, s83, 180224
  buffer_load_dwordx4 v[224:227], v3, s[32:35], s68 offen offset:0 nt
  s_movk_i32 s96, 6
L_w51:
  s_getreg_b32 s97, hwreg(HW_REG_IB_STS, 0, 4)
  s_cmp_lt_u32 s97, 5
  s_cbranch_scc1 L_g51
  s_sub_u32 s96, s96, 1
  s_cbranch_scc0 L_w51
L_g51:
  s_waitcnt vmcnt(6)
  buffer_load_dwordx4 v[228:231], v3, s[32:35], s68 offen offset:512 nt
  s_movk_i32 s96, 6
L_w52:
  s_getreg_b32 s97, hwreg(HW_REG_IB_STS, 0, 4)
  s_cmp_lt_u32 s97, 5
  s_cbranch_scc1 L_g52
  s_sub_u32 s96, s96, 1
  s_cbranch_scc0 L_w52
L_g52:
  s_waitcnt vmcnt(6)
  s_xor_b32 s68, s83, 212992
  buffer_load_dwordx4 v[232:235], v3, s[32:35], s68 offen offset:0 nt
  s_movk_i32 s96, 6
L_w53:
  s_getreg_b32 s97, hwreg(HW_REG_IB_STS, 0, 4)
  s_cmp_lt_u32 s97, 5
  s_cbranch_scc1 L_g53
  s_sub_u32 s96, s96, 1
  s_cbranch_scc0 L_w53
L_g53:
  s_waitcnt vmcnt(6)
  buffer_load_dwordx4 v[236:239], v3, s[32:35], s68 offen offset:512 nt
  s_movk_i32 s96, 6
L_w54:
  s_getreg_b32 s97, hwreg(HW_REG_IB_STS, 0, 4)
  s_cmp_lt_u32 s97, 5
  s_cbranch_scc1 L_g54
  s_sub_u32 s96, s96, 1
  s_cbranch_scc0 L_w54
L_g54:
  s_waitcnt vmcnt(6)
  s_xor_b32 s68, s83, 245760
  buffer_load_dwordx4 v[240:243], v3, s[32:35], s68 offen offset:0 nt
  s_movk_i32 s96, 6
L_w55:
  s_getreg_b32 s97, hwreg(HW_REG_IB_STS, 0, 4)
  s_cmp_lt_u32 s97, 5
  s_cbranch_scc1 L_g55
  s_sub_u32 s96, s96, 1
  s_cbranch_scc0 L_w55
L_g55:
  s_waitcnt vmcnt(6)
  buffer_load_dwordx4 v[244:247], v3, s[32:35], s68 offen offset:512 nt
  v_lshlrev_b32 v50, 2, v0
  v_and_b32 v51, 3, v0
  v_mov_b32 v49, 0
L_qpoll:
  ds_read_b32 v48, v50 offset:0
  s_sub_u32 s79, s79, 1
  s_cbranch_scc1 L_end
  s_waitcnt lgkmcnt(0)
  v_cmp_eq_u32 vcc, -1, v48
  s_nop 1
  s_cbranch_vccnz L_qpoll
  v_cmp_ne_u32 vcc, 0, v51
  s_nop 1
  v_cndmask_b32_dpp v28, v48, v49, vcc quad_perm:[0,0,0,0] row_mask:0xf bank_mask:0xf
  v_cndmask_b32_dpp v29, v48, v49, vcc quad_perm:[1,1,1,1] row_mask:0xf bank_mask:0xf
  v_cndmask_b32_dpp v30, v48, v49, vcc quad_perm:[2,2,2,2] row_mask:0xf bank_mask:0xf
  v_cndmask_b32_dpp v31, v48, v49, vcc quad_perm:[3,3,3,3] row_mask:0xf bank_mask:0xf
  v_cmp_ne_u32 vcc, 1, v51
  s_nop 1
  v_cndmask_b32_dpp v32, v48, v49, vcc quad_perm:[0,0,0,0] row_mask:0xf bank_mask:0xf
  v_cndmask_b32_dpp v33, v48, v49, vcc quad_perm:[1,1,1,1] row_mask:0xf bank_mask:0xf
  v_cndmask_b32_dpp v34, v48, v49, vcc quad_perm:[2,2,2,2] row_mask:0xf bank_mask:0xf
  v_cndmask_b32_dpp v35, v48, v49, vcc quad_perm:[3,3,3,3] row_mask:0xf bank_mask:0xf
  v_cmp_ne_u32 vcc, 2, v51
  s_nop 1
  v_cndmask_b32_dpp v36, v48, v49, vcc quad_perm:[0,0,0,0] row_mask:0xf bank_mask:0xf
  v_cndmask_b32_dpp v37, v48, v49, vcc quad_perm:[1,1,1,1] row_mask:0xf bank_mask:0xf
  v_cndmask_b32_dpp v38, v48, v49, vcc quad_perm:[2,2,2,2] row_mask:0xf bank_mask:0xf
  v_cndmask_b32_dpp v39, v48, v49, vcc quad_perm:[3,3,3,3] row_mask:0xf bank_mask:0xf
  v_cmp_ne_u32 vcc, 3, v51
  s_nop 1
  v_cndmask_b32_dpp v40, v48, v49, vcc quad_perm:[0,0,0,0] row_mask:0xf bank_mask:0xf
  v_cndmask_b32_dpp v41, v48, v49, vcc quad_perm:[1,1,1,1] row_mask:0xf bank_mask:0xf
  v_cndmask_b32_dpp v42, v48, v49, vcc quad_perm:[2,2,2,2] row_mask:0xf bank_mask:0xf
  v_cndmask_b32_dpp v43, v48, v49, vcc quad_perm:[3,3,3,3] row_mask:0xf bank_mask:0xf
  s_movk_i32 s96, 6
L_w56:
  s_getreg_b32 s97, hwreg(HW_REG_IB_STS, 0, 4)
  s_cmp_lt_u32 s97, 5
  s_cbranch_scc1 L_g56
  s_sub_u32 s96, s96, 1
  s_cbranch_scc0 L_w56
L_g56:
  s_waitcnt vmcnt(6)
  s_xor_b32 s68, s83, 135168
  buffer_load_dwordx4 v[248:251], v3, s[32:35], s68 offen offset:0 nt
  v_mfma_f32_16x16x32_bf16 v[20:23], v[56:59], v[28:31], 0
  v_mfma_f32_16x16x32_bf16 v[20:23], v[60:63], v[32:35], v[20:23]
  v_mfma_f32_16x16x32_bf16 v[20:23], v[64:67], v[36:39], v[20:23]
  v_mfma_f32_16x16x32_bf16 v[20:23], v[68:71], v[40:43], v[20:23]
  v_mfma_f32_16x16x32_bf16 v[24:27], v[72:75], v[28:31], 0
  v_mfma_f32_16x16x32_bf16 v[24:27], v[76:79], v[32:35], v[24:27]
  v_mfma_f32_16x16x32_bf16 v[24:27], v[80:83], v[36:39], v[24:27]
  v_mfma_f32_16x16x32_bf16 v[24:27], v[84:87], v[40:43], v[24:27]
  s_nop 3
  v_add_f32_dpp v44, v21, v20 row_ror:12 row_mask:0xf bank_mask:0x1
  s_nop 1
  v_add_f32_dpp v44, v22, v44 row_ror:8 row_mask:0xf bank_mask:0x1
  s_nop 1
  v_add_f32_dpp v44, v23, v44 row_ror:4 row_mask:0xf bank_mask:0x1
  v_mfma_f32_16x16x32_bf16 v[20:23], v[88:91], v[28:31], 0
  v_mfma_f32_16x16x32_bf16 v[20:23], v[92:95], v[32:35], v[20:23]
  v_mfma_f32_16x16x32_bf16 v[20:23], v[96:99], v[36:39], v[20:23]
  v_mfma_f32_16x16x32_bf16 v[20:23], v[100:103], v[40:43], v[20:23]
  v_add_f32_dpp v44, v24, v25 row_ror:4 row_mask:0xf bank_mask:0x2
  s_nop 1
  v_add_f32_dpp v44, v26, v44 row_ror:12 row_mask:0xf bank_mask:0x2
  s_nop 1
  v_add_f32_dpp v44, v27, v44 row_ror:8 row_mask:0xf bank_mask:0x2
  s_movk_i32 s96, 6
L_w57:
  s_getreg_b32 s97, hwreg(HW_REG_IB_STS, 0, 4)
  s_cmp_lt_u32 s97, 5
  s_cbranch_scc1 L_g57
  s_sub_u32 s96, s96, 1
  s_cbranch_scc0 L_w57
L_g57:
  s_waitcnt vmcnt(6)
  buffer_load_dwordx4 v[252:255], v3, s[32:35], s68 offen offset:512 nt
  v_mfma_f32_16x16x32_bf16 v[24:27], v[104:107], v[28:31], 0
  v_mfma_f32_16x16x32_bf16 v[24:27], v[108:111], v[32:35], v[24:27]
  v_mfma_f32_16x16x32_bf16 v[24:27], v[112:115], v[36:39], v[24:27]
  v_mfma_f32_16x16x32_bf16 v[24:27], v[116:119], v[40:43], v[24:27]
  v_add_f32_dpp v44, v20, v22 row_ror:8 row_mask:0xf bank_mask:0x4
  s_nop 1
  v_add_f32_dpp v44, v21, v44 row_ror:4 row_mask:0xf bank_mask:0x4
  s_nop 1
  v_add_f32_dpp v44, v23, v44 row_ror:12 row_mask:0xf bank_mask:0x4
  v_mfma_f32_16x16x32_bf16 v[20:23], v[120:123], v[28:31], 0
  v_mfma_f32_16x16x32_bf16 v[20:23], v[124:127], v[32:35], v[20:23]
  v_mfma_f32_16x16x32_bf16 v[20:23], v[128:131], v[36:39], v[20:23]
  v_mfma_f32_16x16x32_bf16 v[20:23], v[132:135], v[40:43], v[20:23]
  v_add_f32_dpp v44, v24, v27 row_ror:12 row_mask:0xf bank_mask:0x8
  s_nop 1
  v_add_f32_dpp v44, v25, v44 row_ror:8 row_mask:0xf bank_mask:0x8
  s_nop 1
  v_add_f32_dpp v44, v26, v44 row_ror:4 row_mask:0xf bank_mask:0x8
  v_mfma_f32_16x16x32_bf16 v[24:27], v[136:139], v[28:31], 0
  v_mfma_f32_16x16x32_bf16 v[24:27], v[140:143], v[32:35], v[24:27]
  v_mfma_f32_16x16x32_bf16 v[24:27], v[144:147], v[36:39], v[24:27]
  v_mfma_f32_16x16x32_bf16 v[24:27], v[148:151], v[40:43], v[24:27]
  v_add_f32_dpp v45, v21, v20 row_ror:12 row_mask:0xf bank_mask:0x1
  s_nop 1
  v_add_f32_dpp v45, v22, v45 row_ror:8 row_mask:0xf bank_mask:0x1
  s_nop 1
  v_add_f32_dpp v45, v23, v45 row_ror:4 row_mask:0xf bank_mask:0x1
  s_movk_i32 s96, 6
L_w58:
  s_getreg_b32 s97, hwreg(HW_REG_IB_STS, 0, 4)
  s_cmp_lt_u32 s97, 5
  s_cbranch_scc1 L_g58
  s_sub_u32 s96, s96, 1
  s_cbranch_scc0 L_w58
L_g58:
  s_waitcnt vmcnt(6)
  s_xor_b32 s68, s83, 167936
  buffer_load_dwordx4 v[56:59], v3, s[32:35], s68 offen offset:0 nt
  v_mfma_f32_16x16x32_bf16 v[20:23], v[152:155], v[28:31], 0
  v_mfma_f32_16x16x32_bf16 v[20:23], v[156:159], v[32:35], v[20:23]
  v_mfma_f32_16x16x32_bf16 v[20:23], v[160:163], v[36:39], v[20:23]
  v_mfma_f32_16x16x32_bf16 v[20:23], v[164:167], v[40:43], v[20:23]
  v_add_f32_dpp v45, v24, v25 row_ror:4 row_mask:0xf bank_mask:0x2
  s_nop 1
  v_add_f32_dpp v45, v26, v45 row_ror:12 row_mask:0xf bank_mask:0x2
  s_nop 1
  v_add_f32_dpp v45, v27, v45 row_ror:8 row_mask:0xf bank_mask:0x2
  v_mfma_f32_16x16x32_bf16 v[24:27], v[168:171], v[28:31], 0
  v_mfma_f32_16x16x32_bf16 v[24:27], v[172:175], v[32:35], v[24:27]
  v_mfma_f32_16x16x32_bf16 v[24:27], v[176:179], v[36:39], v[24:27]
  v_mfma_f32_16x16x32_bf16 v[24:27], v[180:183], v[40:43], v[24:27]
  v_add_f32_dpp v45, v20, v22 row_ror:8 row_mask:0xf bank_mask:0x4
  s_nop 1
  v_add_f32_dpp v45, v21, v45 row_ror:4 row_mask:0xf bank_mask:0x4
  s_nop 1
  v_add_f32_dpp v45, v23, v45 row_ror:12 row_mask:0xf bank_mask:0x4
  v_mfma_f32_16x16x32_bf16 v[20:23], v[184:187], v[28:31], 0
  v_mfma_f32_16x16x32_bf16 v[20:23], v[188:191], v[32:35], v[20:23]
  v_mfma_f32_16x16x32_bf16 v[20:23], v[192:195], v[36:39], v[20:23]
  v_mfma_f32_16x16x32_bf16 v[20:23], v[196:199], v[40:43], v[20:23]
  v_add_f32_dpp v45, v24, v27 row_ror:12 row_mask:0xf bank_mask:0x8
  s_nop 1
  v_add_f32_dpp v45, v25, v45 row_ror:8 row_mask:0xf bank_mask:0x8
  s_nop 1
  v_add_f32_dpp v45, v26, v45 row_ror:4 row_mask:0xf bank_mask:0x8
  s_movk_i32 s96, 6
L_w59:
  s_getreg_b32 s97, hwreg(HW_REG_IB_STS, 0, 4)
  s_cmp_lt_u32 s97, 5
  s_cbranch_scc1 L_g59
  s_sub_u32 s96, s96, 1
  s_cbranch_scc0 L_w59
L_g59:
  s_waitcnt vmcnt(6)
  buffer_load_dwordx4 v[60:63], v3, s[32:35], s68 offen offset:512 nt
  v_mfma_f32_16x16x32_bf16 v[24:27], v[200:203], v[28:31], 0
  v_mfma_f32_16x16x32_bf16 v[24:27], v[204:207], v[32:35], v[24:27]
  v_mfma_f32_16x16x32_bf16 v[24:27], v[208:211], v[36:39], v[24:27]
  v_mfma_f32_16x16x32_bf16 v[24:27], v[212:215], v[40:43], v[24:27]
  v_add_f32_dpp v46, v21, v20 row_ror:12 row_mask:0xf bank_mask:0x1
  s_nop 1
  v_add_f32_dpp v46, v22, v46 row_ror:8 row_mask:0xf bank_mask:0x1
  s_nop 1
  v_add_f32_dpp v46, v23, v46 row_ror:4 row_mask:0xf bank_mask:0x1
  v_mfma_f32_16x16x32_bf16 v[20:23], v[216:219], v[28:31], 0
  v_mfma_f32_16x16x32_bf16 v[20:23], v[220:223], v[32:35], v[20:23]
  v_mfma_f32_16x16x32_bf16 v[20:23], v[224:227], v[36:39], v[20:23]
  v_mfma_f32_16x16x32_bf16 v[20:23], v[228:231], v[40:43], v[20:23]
  v_add_f32_dpp v46, v24, v25 row_ror:4 row_mask:0xf bank_mask:0x2
  s_nop 1
  v_add_f32_dpp v46, v26, v46 row_ror:12 row_mask:0xf bank_mask:0x2
  s_nop 1
  v_add_f32_dpp v46, v27, v46 row_ror:8 row_mask:0xf bank_mask:0x2
  s_movk_i32 s96, 6
L_w60:
  s_getreg_b32 s97, hwreg(HW_REG_IB_STS, 0, 4)
  s_cmp_lt_u32 s97, 5
  s_cbranch_scc1 L_g60
  s_sub_u32 s96, s96, 1
  s_cbranch_scc0 L_w60
L_g60:
  s_waitcnt vmcnt(6)
  s_xor_b32 s68, s83, 200704
  buffer_load_dwordx4 v[64:67], v3, s[32:35], s68 offen offset:0 nt
  s_movk_i32 s96, 6
L_w61:
  s_getreg_b32 s97, hwreg(HW_REG_IB_STS, 0, 4)
  s_cmp_lt_u32 s97, 5
  s_cbranch_scc1 L_g61
  s_sub_u32 s96, s96, 1
  s_cbranch_scc0 L_w61
L_g61:
  s_waitcnt vmcnt(6)
  buffer_load_dwordx4 v[68:71], v3, s[32:35], s68 offen offset:512 nt
  s_movk_i32 s96, 6
L_w62:
  s_getreg_b32 s97, hwreg(HW_REG_IB_STS, 0, 4)
  s_cmp_lt_u32 s97, 5
  s_cbranch_scc1 L_g62
  s_sub_u32 s96, s96, 1
  s_cbranch_scc0 L_w62
L_g62:
  s_waitcnt vmcnt(6)
  s_xor_b32 s68, s83, 233472
  buffer_load_dwordx4 v[72:75], v3, s[32:35], s68 offen offset:0 nt
  v_mfma_f32_16x16x32_bf16 v[24:27], v[232:235], v[28:31], 0
  v_mfma_f32_16x16x32_bf16 v[24:27], v[236:239], v[32:35], v[24:27]
  v_mfma_f32_16x16x32_bf16 v[24:27], v[240:243], v[36:39], v[24:27]
  v_mfma_f32_16x16x32_bf16 v[24:27], v[244:247], v[40:43], v[24:27]
  v_add_f32_dpp v46, v20, v22 row_ror:8 row_mask:0xf bank_mask:0x4
  s_nop 1
  v_add_f32_dpp v46, v21, v46 row_ror:4 row_mask:0xf bank_mask:0x4
  s_nop 1
  v_add_f32_dpp v46, v23, v46 row_ror:12 row_mask:0xf bank_mask:0x4
  s_movk_i32 s96, 6
L_w63:
  s_getreg_b32 s97, hwreg(HW_REG_IB_STS, 0, 4)
  s_cmp_lt_u32 s97, 5
  s_cbranch_scc1 L_g63
  s_sub_u32 s96, s96, 1
  s_cbranch_scc0 L_w63
L_g63:
  s_waitcnt vmcnt(6)
  buffer_load_dwordx4 v[76:79], v3, s[32:35], s68 offen offset:512 nt
  s_movk_i32 s96, 6
L_w64:
  s_getreg_b32 s97, hwreg(HW_REG_IB_STS, 0, 4)
  s_cmp_lt_u32 s97, 5
  s_cbranch_scc1 L_g64
  s_sub_u32 s96, s96, 1
  s_cbranch_scc0 L_w64
L_g64:
  s_waitcnt vmcnt(6)
  s_xor_b32 s68, s83, 151552
  buffer_load_dwordx4 v[80:83], v3, s[32:35], s68 offen offset:0 nt
  s_movk_i32 s96, 6
L_w65:
  s_getreg_b32 s97, hwreg(HW_REG_IB_STS, 0, 4)
  s_cmp_lt_u32 s97, 5
  s_cbranch_scc1 L_g65
  s_sub_u32 s96, s96, 1
  s_cbranch_scc0 L_w65
L_g65:
  s_waitcnt vmcnt(6)
  buffer_load_dwordx4 v[84:87], v3, s[32:35], s68 offen offset:512 nt
  s_movk_i32 s96, 6
L_w66:
  s_getreg_b32 s97, hwreg(HW_REG_IB_STS, 0, 4)
  s_cmp_lt_u32 s97, 5
  s_cbranch_scc1 L_g66
  s_sub_u32 s96, s96, 1
  s_cbranch_scc0 L_w66
L_g66:
  s_waitcnt vmcnt(6)
  s_xor_b32 s68, s83, 184320
  buffer_load_dwordx4 v[88:91], v3, s[32:35], s68 offen offset:0 nt
  v_mfma_f32_16x16x32_bf16 v[20:23], v[248:251], v[28:31], 0
  v_mfma_f32_16x16x32_bf16 v[20:23], v[252:255], v[32:35], v[20:23]
  v_mfma_f32_16x16x32_bf16 v[20:23], v[56:59], v[36:39], v[20:23]
  v_mfma_f32_16x16x32_bf16 v[20:23], v[60:63], v[40:43], v[20:23]
  v_add_f32_dpp v46, v24, v27 row_ror:12 row_mask:0xf bank_mask:0x8
  s_nop 1
  v_add_f32_dpp v46, v25, v46 row_ror:8 row_mask:0xf bank_mask:0x8
  s_nop 1
  v_add_f32_dpp v46, v26, v46 row_ror:4 row_mask:0xf bank_mask:0x8
  s_movk_i32 s96, 6
L_w67:
  s_getreg_b32 s97, hwreg(HW_REG_IB_STS, 0, 4)
  s_cmp_lt_u32 s97, 5
  s_cbranch_scc1 L_g67
  s_sub_u32 s96, s96, 1
  s_cbranch_scc0 L_w67
L_g67:
  s_waitcnt vmcnt(6)
  buffer_load_dwordx4 v[92:95], v3, s[32:35], s68 offen offset:512 nt
  s_movk_i32 s96, 6
L_w68:
  s_getreg_b32 s97, hwreg(HW_REG_IB_STS, 0, 4)
  s_cmp_lt_u32 s97, 5
  s_cbranch_scc1 L_g68
  s_sub_u32 s96, s96, 1
  s_cbranch_scc0 L_w68
L_g68:
  s_waitcnt vmcnt(6)
  s_xor_b32 s68, s83, 217088
  buffer_load_dwordx4 v[96:99], v3, s[32:35], s68 offen offset:0 nt
  s_movk_i32 s96, 6
L_w69:
  s_getreg_b32 s97, hwreg(HW_REG_IB_STS, 0, 4)
  s_cmp_lt_u32 s97, 5
  s_cbranch_scc1 L_g69
  s_sub_u32 s96, s96, 1
  s_cbranch_scc0 L_w69
L_g69:
  s_waitcnt vmcnt(6)
  buffer_load_dwordx4 v[100:103], v3, s[32:35], s68 offen offset:512 nt
  s_movk_i32 s96, 6
L_w70:
  s_getreg_b32 s97, hwreg(HW_REG_IB_STS, 0, 4)
  s_cmp_lt_u32 s97, 5
  s_cbranch_scc1 L_g70
  s_sub_u32 s96, s96, 1
  s_cbranch_scc0 L_w70
L_g70:
  s_waitcnt vmcnt(6)
  s_xor_b32 s68, s83, 249856
  buffer_load_dwordx4 v[104:107], v3, s[32:35], s68 offen offset:0 nt
  v_mfma_f32_16x16x32_bf16 v[24:27], v[64:67], v[28:31], 0
  v_mfma_f32_16x16x32_bf16 v[24:27], v[68:71], v[32:35], v[24:27]
  v_mfma_f32_16x16x32_bf16 v[24:27], v[72:75], v[36:39], v[24:27]
  v_mfma_f32_16x16x32_bf16 v[24:27], v[76:79], v[40:43], v[24:27]
  v_add_f32_dpp v47, v21, v20 row_ror:12 row_mask:0xf bank_mask:0x1
  s_nop 1
  v_add_f32_dpp v47, v22, v47 row_ror:8 row_mask:0xf bank_mask:0x1
  s_nop 1
  v_add_f32_dpp v47, v23, v47 row_ror:4 row_mask:0xf bank_mask:0x1
  s_movk_i32 s96, 6
L_w71:
  s_getreg_b32 s97, hwreg(HW_REG_IB_STS, 0, 4)
  s_cmp_lt_u32 s97, 5
  s_cbranch_scc1 L_g71
  s_sub_u32 s96, s96, 1
  s_cbranch_scc0 L_w71
L_g71:
  s_waitcnt vmcnt(6)
  buffer_load_dwordx4 v[108:111], v3, s[32:35], s68 offen offset:512 nt
  s_movk_i32 s96, 6
L_w72:
  s_getreg_b32 s97, hwreg(HW_REG_IB_STS, 0, 4)
  s_cmp_lt_u32 s97, 5
  s_cbranch_scc1 L_g72
  s_sub_u32 s96, s96, 1
  s_cbranch_scc0 L_w72
L_g72:
  s_waitcnt vmcnt(6)
  buffer_load_dwordx4 v[112:115], v6, s[36:39], s83 offen offset:0 nt
  s_movk_i32 s96, 6
L_w73:
  s_getreg_b32 s97, hwreg(HW_REG_IB_STS, 0, 4)
  s_cmp_lt_u32 s97, 5
  s_cbranch_scc1 L_g73
  s_sub_u32 s96, s96, 1
  s_cbranch_scc0 L_w73
L_g73:
  s_waitcnt vmcnt(6)
  buffer_load_dwordx4 v[116:119], v6, s[36:39], s83 offen offset:512 nt
  s_movk_i32 s96, 6
L_w74:
  s_getreg_b32 s97, hwreg(HW_REG_IB_STS, 0, 4)
  s_cmp_lt_u32 s97, 5
  s_cbranch_scc1 L_g74
  s_sub_u32 s96, s96, 1
  s_cbranch_scc0 L_w74
L_g74:
  s_waitcnt vmcnt(6)
  s_xor_b32 s68, s83, 32768
  buffer_load_dwordx4 v[120:123], v6, s[36:39], s68 offen offset:0 nt
  v_mfma_f32_16x16x32_bf16 v[20:23], v[80:83], v[28:31], 0
  v_mfma_f32_16x16x32_bf16 v[20:23], v[84:87], v[32:35], v[20:23]
  v_mfma_f32_16x16x32_bf16 v[20:23], v[88:91], v[36:39], v[20:23]
  v_mfma_f32_16x16x32_bf16 v[20:23], v[92:95], v[40:43], v[20:23]
  v_add_f32_dpp v47, v24, v25 row_ror:4 row_mask:0xf bank_mask:0x2
  s_nop 1
  v_add_f32_dpp v47, v26, v47 row_ror:12 row_mask:0xf bank_mask:0x2
  s_nop 1
  v_add_f32_dpp v47, v27, v47 row_ror:8 row_mask:0xf bank_mask:0x2
  s_movk_i32 s96, 6
L_w75:
  s_getreg_b32 s97, hwreg(HW_REG_IB_STS, 0, 4)
  s_cmp_lt_u32 s97, 5
  s_cbranch_scc1 L_g75
  s_sub_u32 s96, s96, 1
  s_cbranch_scc0 L_w75
L_g75:
  s_waitcnt vmcnt(6)
  buffer_load_dwordx4 v[124:127], v6, s[36:39], s68 offen offset:512 nt
  s_movk_i32 s96, 6
L_w76:
  s_getreg_b32 s97, hwreg(HW_REG_IB_STS, 0, 4)
  s_cmp_lt_u32 s97, 5
  s_cbranch_scc1 L_g76
  s_sub_u32 s96, s96, 1
  s_cbranch_scc0 L_w76
L_g76:
  s_waitcnt vmcnt(6)
  s_xor_b32 s68, s83, 65536
  buffer_load_dwordx4 v[128:131], v6, s[36:39], s68 offen offset:0 nt
  s_movk_i32 s96, 6
L_w77:
  s_getreg_b32 s97, hwreg(HW_REG_IB_STS, 0, 4)
  s_cmp_lt_u32 s97, 5
  s_cbranch_scc1 L_g77
  s_sub_u32 s96, s96, 1
  s_cbranch_scc0 L_w77
L_g77:
  s_waitcnt vmcnt(6)
  buffer_load_dwordx4 v[132:135], v6, s[36:39], s68 offen offset:512 nt
  s_movk_i32 s96, 6
L_w78:
  s_getreg_b32 s97, hwreg(HW_REG_IB_STS, 0, 4)
  s_cmp_lt_u32 s97, 5
  s_cbranch_scc1 L_g78
  s_sub_u32 s96, s96, 1
  s_cbranch_scc0 L_w78
L_g78:
  s_waitcnt vmcnt(6)
  s_xor_b32 s68, s83, 98304
  buffer_load_dwordx4 v[136:139], v6, s[36:39], s68 offen offset:0 nt
  v_mfma_f32_16x16x32_bf16 v[24:27], v[96:99], v[28:31], 0
  v_mfma_f32_16x16x32_bf16 v[24:27], v[100:103], v[32:35], v[24:27]
  v_mfma_f32_16x16x32_bf16 v[24:27], v[104:107], v[36:39], v[24:27]
  v_mfma_f32_16x16x32_bf16 v[24:27], v[108:111], v[40:43], v[24:27]
  v_add_f32_dpp v47, v20, v22 row_ror:8 row_mask:0xf bank_mask:0x4
  s_nop 1
  v_add_f32_dpp v47, v21, v47 row_ror:4 row_mask:0xf bank_mask:0x4
  s_nop 1
  v_add_f32_dpp v47, v23, v47 row_ror:12 row_mask:0xf bank_mask:0x4
  s_nop 1
  v_add_f32_dpp v47, v24, v27 row_ror:12 row_mask:0xf bank_mask:0x8
  s_nop 1
  v_add_f32_dpp v47, v25, v47 row_ror:8 row_mask:0xf bank_mask:0x8
  s_nop 1
  v_add_f32_dpp v47, v26, v47 row_ror:4 row_mask:0xf bank_mask:0x8
  s_mov_b32 s74, 0x3db504f3
  v_cvt_pk_bf16_f32 v45, v44, v45
  v_lshlrev_b32 v44, 16, v45
  v_and_b32 v45, 0xffff0000, v45
  v_mul_f32 v44, s74, v44
  v_mul_f32 v45, s74, v45
  v_cvt_pk_bf16_f32 v45, v44, v45
  v_lshlrev_b32 v44, 16, v45
  v_and_b32 v45, 0xffff0000, v45
  v_cvt_pk_bf16_f32 v47, v46, v47
  v_lshlrev_b32 v46, 16, v47
  v_and_b32 v47, 0xffff0000, v47
  v_mul_f32 v46, s74, v46
  v_mul_f32 v47, s74, v47
  v_cvt_pk_bf16_f32 v47, v46, v47
  v_lshlrev_b32 v46, 16, v47
  v_and_b32 v47, 0xffff0000, v47
  v_max3_f32 v52, v44, v45, v46
  v_max_f32 v52, v52, v47
  s_nop 1
  v_max_f32_dpp v52, v52, v52 quad_perm:[1,0,3,2] row_mask:0xf bank_mask:0xf
  s_nop 1
  v_max_f32_dpp v52, v52, v52 quad_perm:[2,3,0,1] row_mask:0xf bank_mask:0xf
  s_nop 1
  v_max_f32_dpp v52, v52, v52 row_ror:4 row_mask:0xf bank_mask:0xf
  s_nop 1
  v_max_f32_dpp v52, v52, v52 row_ror:8 row_mask:0xf bank_mask:0xf
  v_mov_b32 v51, v52
  s_nop 1
  v_permlane16_swap_b32 v52, v51
  v_max_f32 v52, v52, v51
  v_mov_b32 v51, v52
  s_nop 1
  v_permlane32_swap_b32 v52, v51
  v_max_f32 v52, v52, v51
  s_movk_i32 s96, 6
L_w79:
  s_getreg_b32 s97, hwreg(HW_REG_IB_STS, 0, 4)
  s_cmp_lt_u32 s97, 5
  s_cbranch_scc1 L_g79
  s_sub_u32 s96, s96, 1
  s_cbranch_scc0 L_w79
L_g79:
  s_waitcnt vmcnt(6)
  buffer_load_dwordx4 v[140:143], v6, s[36:39], s68 offen offset:512 nt
  v_sub_f32 v44, v44, v52
  v_sub_f32 v45, v45, v52
  v_sub_f32 v46, v46, v52
  v_sub_f32 v47, v47, v52
  v_mul_f32 v44, 0x3fb8aa3b, v44
  v_mul_f32 v45, 0x3fb8aa3b, v45
  v_mul_f32 v46, 0x3fb8aa3b, v46
  v_mul_f32 v47, 0x3fb8aa3b, v47
  v_exp_f32 v44, v44
  v_exp_f32 v45, v45
  v_exp_f32 v46, v46
  v_exp_f32 v47, v47
  s_lshl_b32 s74, s3, 3
  v_pk_add_f32 v[48:49], v[44:45], v[46:47]
  v_add_f32 v53, v48, v49
  s_nop 1
  v_add_f32_dpp v53, v53, v53 quad_perm:[1,0,3,2] row_mask:0xf bank_mask:0xf
  s_nop 1
  v_add_f32_dpp v53, v53, v53 quad_perm:[2,3,0,1] row_mask:0xf bank_mask:0xf
  s_nop 1
  v_add_f32_dpp v53, v53, v53 row_ror:4 row_mask:0xf bank_mask:0xf
  s_nop 1
  v_add_f32_dpp v53, v53, v53 row_ror:8 row_mask:0xf bank_mask:0xf
  v_mov_b32 v51, v53
  s_nop 1
  v_permlane16_swap_b32 v53, v51
  v_add_f32 v53, v53, v51
  v_mov_b32 v51, v53
  s_nop 1
  v_permlane32_swap_b32 v53, v51
  v_add_f32 v53, v53, v51
  v_min_u32 v52, -2, v52
  v_min_u32 v53, -2, v53
  v_mov_b32 v51, s74
  s_mov_b64 exec, 1
  ds_write_b64 v51, v[52:53] offset:256
  s_mov_b64 exec, -1
  s_movk_i32 s96, 6
L_w80:
  s_getreg_b32 s97, hwreg(HW_REG_IB_STS, 0, 4)
  s_cmp_lt_u32 s97, 5
  s_cbranch_scc1 L_g80
  s_sub_u32 s96, s96, 1
  s_cbranch_scc0 L_w80
L_g80:
  s_waitcnt vmcnt(6)
  s_xor_b32 s68, s83, 16384
  buffer_load_dwordx4 v[144:147], v6, s[36:39], s68 offen offset:0 nt
  s_movk_i32 s96, 6
L_w81:
  s_getreg_b32 s97, hwreg(HW_REG_IB_STS, 0, 4)
  s_cmp_lt_u32 s97, 5
  s_cbranch_scc1 L_g81
  s_sub_u32 s96, s96, 1
  s_cbranch_scc0 L_w81
L_g81:
  s_waitcnt vmcnt(6)
  buffer_load_dwordx4 v[148:151], v6, s[36:39], s68 offen offset:512 nt
  v_mov_b32 v51, 0
L_mlpoll:
  ds_read_b128 v[28:31], v51 offset:256
  ds_read_b128 v[32:35], v51 offset:272
  s_sub_u32 s79, s79, 1
  s_cbranch_scc1 L_end
  s_waitcnt lgkmcnt(0)
  v_max3_u32 v48, v28, v29, v30
  v_max3_u32 v49, v31, v32, v33
  v_max3_u32 v48, v48, v34, v35
  v_max_u32 v48, v48, v49
  v_cmp_eq_u32 vcc, -1, v48
  s_nop 1
  s_cbranch_vccnz L_mlpoll
  v_max3_f32 v50, v28, v30, v32
  v_max_f32 v50, v50, v34
  v_sub_f32 v28, v28, v50
  v_sub_f32 v30, v30, v50
  v_sub_f32 v32, v32, v50
  v_sub_f32 v34, v34, v50
  v_sub_f32 v52, v52, v50
  v_mul_f32 v28, 0x3fb8aa3b, v28
  v_mul_f32 v30, 0x3fb8aa3b, v30
  v_mul_f32 v32, 0x3fb8aa3b, v32
  v_mul_f32 v34, 0x3fb8aa3b, v34
  v_mul_f32 v52, 0x3fb8aa3b, v52
  v_exp_f32 v28, v28
  v_exp_f32 v30, v30
  v_exp_f32 v32, v32
  v_exp_f32 v34, v34
  v_exp_f32 v52, v52
  v_mul_f32 v53, v28, v29
  v_fmac_f32 v53, v30, v31
  v_fmac_f32 v53, v32, v33
  v_fmac_f32 v53, v34, v35
  v_rcp_f32 v53, v53
  s_nop 0
  v_mul_f32 v52, v52, v53
  v_mul_f32 v44, v44, v52
  v_mul_f32 v45, v45, v52
  v_mul_f32 v46, v46, v52
  v_mul_f32 v47, v47, v52
  v_cvt_pk_bf16_f32 v44, v44, v44
  v_cvt_pk_bf16_f32 v45, v45, v45
  v_cvt_pk_bf16_f32 v46, v46, v46
  v_cvt_pk_bf16_f32 v47, v47, v47
  v_and_b32_dpp v12, v44, v8 row_newbcast:0 row_mask:0xf bank_mask:0xf
  v_and_b32_dpp v13, v44, v9 row_newbcast:0 row_mask:0xf bank_mask:0xf
  v_and_b32_dpp v14, v44, v10 row_newbcast:0 row_mask:0xf bank_mask:0xf
  v_and_b32_dpp v15, v44, v11 row_newbcast:0 row_mask:0xf bank_mask:0xf
  v_mov_b32 v26, s84
  v_mov_b32 v27, s85
  s_lshl_b32 s74, s3, 2
  v_mov_b32 v50, s74
  v_mov_b32 v54, 1
  s_movk_i32 s96, 6
L_w82:
  s_getreg_b32 s97, hwreg(HW_REG_IB_STS, 0, 4)
  s_cmp_lt_u32 s97, 5
  s_cbranch_scc1 L_g82
  s_sub_u32 s96, s96, 1
  s_cbranch_scc0 L_w82
L_g82:
  s_waitcnt vmcnt(6)
  s_xor_b32 s68, s83, 49152
  buffer_load_dwordx4 v[152:155], v6, s[36:39], s68 offen offset:0 nt
  v_and_b32_dpp v16, v44, v8 row_newbcast:1 row_mask:0xf bank_mask:0xf
  v_and_b32_dpp v17, v44, v9 row_newbcast:1 row_mask:0xf bank_mask:0xf
  v_and_b32_dpp v18, v44, v10 row_newbcast:1 row_mask:0xf bank_mask:0xf
  v_and_b32_dpp v19, v44, v11 row_newbcast:1 row_mask:0xf bank_mask:0xf
  v_mfma_f32_16x16x32_bf16 v[20:23], v[12:15], v[112:115], 0
  v_and_b32_dpp v12, v44, v8 row_newbcast:2 row_mask:0xf bank_mask:0xf
  v_and_b32_dpp v13, v44, v9 row_newbcast:2 row_mask:0xf bank_mask:0xf
  v_and_b32_dpp v14, v44, v10 row_newbcast:2 row_mask:0xf bank_mask:0xf
  v_and_b32_dpp v15, v44, v11 row_newbcast:2 row_mask:0xf bank_mask:0xf
  v_mfma_f32_16x16x32_bf16 v[20:23], v[16:19], v[116:119], v[20:23]
  v_and_b32_dpp v16, v44, v8 row_newbcast:3 row_mask:0xf bank_mask:0xf
  v_and_b32_dpp v17, v44, v9 row_newbcast:3 row_mask:0xf bank_mask:0xf
  v_and_b32_dpp v18, v44, v10 row_newbcast:3 row_mask:0xf bank_mask:0xf
  v_and_b32_dpp v19, v44, v11 row_newbcast:3 row_mask:0xf bank_mask:0xf
  v_mfma_f32_16x16x32_bf16 v[20:23], v[12:15], v[120:123], v[20:23]
  v_and_b32_dpp v12, v44, v8 row_newbcast:4 row_mask:0xf bank_mask:0xf
  v_and_b32_dpp v13, v44, v9 row_newbcast:4 row_mask:0xf bank_mask:0xf
  v_and_b32_dpp v14, v44, v10 row_newbcast:4 row_mask:0xf bank_mask:0xf
  v_and_b32_dpp v15, v44, v11 row_newbcast:4 row_mask:0xf bank_mask:0xf
  v_mfma_f32_16x16x32_bf16 v[20:23], v[16:19], v[124:127], v[20:23]
  s_movk_i32 s96, 6
L_w83:
  s_getreg_b32 s97, hwreg(HW_REG_IB_STS, 0, 4)
  s_cmp_lt_u32 s97, 5
  s_cbranch_scc1 L_g83
  s_sub_u32 s96, s96, 1
  s_cbranch_scc0 L_w83
L_g83:
  s_waitcnt vmcnt(6)
  buffer_load_dwordx4 v[156:159], v6, s[36:39], s68 offen offset:512 nt
  v_and_b32_dpp v16, v44, v8 row_newbcast:5 row_mask:0xf bank_mask:0xf
  v_and_b32_dpp v17, v44, v9 row_newbcast:5 row_mask:0xf bank_mask:0xf
  v_and_b32_dpp v18, v44, v10 row_newbcast:5 row_mask:0xf bank_mask:0xf
  v_and_b32_dpp v19, v44, v11 row_newbcast:5 row_mask:0xf bank_mask:0xf
  v_mfma_f32_16x16x32_bf16 v[20:23], v[12:15], v[128:131], v[20:23]
  s_movk_i32 s96, 6
L_w84:
  s_getreg_b32 s97, hwreg(HW_REG_IB_STS, 0, 4)
  s_cmp_lt_u32 s97, 5
  s_cbranch_scc1 L_g84
  s_sub_u32 s96, s96, 1
  s_cbranch_scc0 L_w84
L_g84:
  s_waitcnt vmcnt(6)
  s_xor_b32 s68, s83, 81920
  buffer_load_dwordx4 v[160:163], v6, s[36:39], s68 offen offset:0 nt
  v_and_b32_dpp v12, v44, v8 row_newbcast:6 row_mask:0xf bank_mask:0xf
  v_and_b32_dpp v13, v44, v9 row_newbcast:6 row_mask:0xf bank_mask:0xf
  v_and_b32_dpp v14, v44, v10 row_newbcast:6 row_mask:0xf bank_mask:0xf
  v_and_b32_dpp v15, v44, v11 row_newbcast:6 row_mask:0xf bank_mask:0xf
  v_mfma_f32_16x16x32_bf16 v[20:23], v[16:19], v[132:135], v[20:23]
  s_movk_i32 s96, 6
L_w85:
  s_getreg_b32 s97, hwreg(HW_REG_IB_STS, 0, 4)
  s_cmp_lt_u32 s97, 5
  s_cbranch_scc1 L_g85
  s_sub_u32 s96, s96, 1
  s_cbranch_scc0 L_w85
L_g85:
  s_waitcnt vmcnt(6)
  buffer_load_dwordx4 v[164:167], v6, s[36:39], s68 offen offset:512 nt
  v_and_b32_dpp v16, v44, v8 row_newbcast:7 row_mask:0xf bank_mask:0xf
  v_and_b32_dpp v17, v44, v9 row_newbcast:7 row_mask:0xf bank_mask:0xf
  v_and_b32_dpp v18, v44, v10 row_newbcast:7 row_mask:0xf bank_mask:0xf
  v_and_b32_dpp v19, v44, v11 row_newbcast:7 row_mask:0xf bank_mask:0xf
  v_mfma_f32_16x16x32_bf16 v[20:23], v[12:15], v[136:139], v[20:23]
  s_movk_i32 s96, 6
L_w86:
  s_getreg_b32 s97, hwreg(HW_REG_IB_STS, 0, 4)
  s_cmp_lt_u32 s97, 5
  s_cbranch_scc1 L_g86
  s_sub_u32 s96, s96, 1
  s_cbranch_scc0 L_w86
L_g86:
  s_waitcnt vmcnt(6)
  s_xor_b32 s68, s83, 114688
  buffer_load_dwordx4 v[168:171], v6, s[36:39], s68 offen offset:0 nt
  v_and_b32_dpp v12, v44, v8 row_newbcast:8 row_mask:0xf bank_mask:0xf
  v_and_b32_dpp v13, v44, v9 row_newbcast:8 row_mask:0xf bank_mask:0xf
  v_and_b32_dpp v14, v44, v10 row_newbcast:8 row_mask:0xf bank_mask:0xf
  v_and_b32_dpp v15, v44, v11 row_newbcast:8 row_mask:0xf bank_mask:0xf
  v_mfma_f32_16x16x32_bf16 v[20:23], v[16:19], v[140:143], v[20:23]
  s_movk_i32 s96, 6
L_w87:
  s_getreg_b32 s97, hwreg(HW_REG_IB_STS, 0, 4)
  s_cmp_lt_u32 s97, 5
  s_cbranch_scc1 L_g87
  s_sub_u32 s96, s96, 1
  s_cbranch_scc0 L_w87
L_g87:
  s_waitcnt vmcnt(6)
  buffer_load_dwordx4 v[172:175], v6, s[36:39], s68 offen offset:512 nt
  v_and_b32_dpp v16, v44, v8 row_newbcast:9 row_mask:0xf bank_mask:0xf
  v_and_b32_dpp v17, v44, v9 row_newbcast:9 row_mask:0xf bank_mask:0xf
  v_and_b32_dpp v18, v44, v10 row_newbcast:9 row_mask:0xf bank_mask:0xf
  v_and_b32_dpp v19, v44, v11 row_newbcast:9 row_mask:0xf bank_mask:0xf
  v_mfma_f32_16x16x32_bf16 v[20:23], v[12:15], v[144:147], v[20:23]
  s_movk_i32 s96, 6
L_w88:
  s_getreg_b32 s97, hwreg(HW_REG_IB_STS, 0, 4)
  s_cmp_lt_u32 s97, 5
  s_cbranch_scc1 L_g88
  s_sub_u32 s96, s96, 1
  s_cbranch_scc0 L_w88
L_g88:
  s_waitcnt vmcnt(6)
  s_xor_b32 s68, s83, 4096
  buffer_load_dwordx4 v[176:179], v6, s[36:39], s68 offen offset:0 nt
  v_and_b32_dpp v12, v44, v8 row_newbcast:10 row_mask:0xf bank_mask:0xf
  v_and_b32_dpp v13, v44, v9 row_newbcast:10 row_mask:0xf bank_mask:0xf
  v_and_b32_dpp v14, v44, v10 row_newbcast:10 row_mask:0xf bank_mask:0xf
  v_and_b32_dpp v15, v44, v11 row_newbcast:10 row_mask:0xf bank_mask:0xf
  v_mfma_f32_16x16x32_bf16 v[20:23], v[16:19], v[148:151], v[20:23]
  s_movk_i32 s96, 6
L_w89:
  s_getreg_b32 s97, hwreg(HW_REG_IB_STS, 0, 4)
  s_cmp_lt_u32 s97, 5
  s_cbranch_scc1 L_g89
  s_sub_u32 s96, s96, 1
  s_cbranch_scc0 L_w89
L_g89:
  s_waitcnt vmcnt(6)
  buffer_load_dwordx4 v[180:183], v6, s[36:39], s68 offen offset:512 nt
  v_and_b32_dpp v16, v44, v8 row_newbcast:11 row_mask:0xf bank_mask:0xf
  v_and_b32_dpp v17, v44, v9 row_newbcast:11 row_mask:0xf bank_mask:0xf
  v_and_b32_dpp v18, v44, v10 row_newbcast:11 row_mask:0xf bank_mask:0xf
  v_and_b32_dpp v19, v44, v11 row_newbcast:11 row_mask:0xf bank_mask:0xf
  v_mfma_f32_16x16x32_bf16 v[20:23], v[12:15], v[152:155], v[20:23]
  s_movk_i32 s96, 6
L_w90:
  s_getreg_b32 s97, hwreg(HW_REG_IB_STS, 0, 4)
  s_cmp_lt_u32 s97, 5
  s_cbranch_scc1 L_g90
  s_sub_u32 s96, s96, 1
  s_cbranch_scc0 L_w90
L_g90:
  s_waitcnt vmcnt(6)
  s_xor_b32 s68, s83, 36864
  buffer_load_dwordx4 v[184:187], v6, s[36:39], s68 offen offset:0 nt
  v_and_b32_dpp v12, v44, v8 row_newbcast:12 row_mask:0xf bank_mask:0xf
  v_and_b32_dpp v13, v44, v9 row_newbcast:12 row_mask:0xf bank_mask:0xf
  v_and_b32_dpp v14, v44, v10 row_newbcast:12 row_mask:0xf bank_mask:0xf
  v_and_b32_dpp v15, v44, v11 row_newbcast:12 row_mask:0xf bank_mask:0xf
  v_mfma_f32_16x16x32_bf16 v[20:23], v[16:19], v[156:159], v[20:23]
  s_movk_i32 s96, 6
L_w91:
  s_getreg_b32 s97, hwreg(HW_REG_IB_STS, 0, 4)
  s_cmp_lt_u32 s97, 5
  s_cbranch_scc1 L_g91
  s_sub_u32 s96, s96, 1
  s_cbranch_scc0 L_w91
L_g91:
  s_waitcnt vmcnt(6)
  buffer_load_dwordx4 v[188:191], v6, s[36:39], s68 offen offset:512 nt
  v_and_b32_dpp v16, v44, v8 row_newbcast:13 row_mask:0xf bank_mask:0xf
  v_and_b32_dpp v17, v44, v9 row_newbcast:13 row_mask:0xf bank_mask:0xf
  v_and_b32_dpp v18, v44, v10 row_newbcast:13 row_mask:0xf bank_mask:0xf
  v_and_b32_dpp v19, v44, v11 row_newbcast:13 row_mask:0xf bank_mask:0xf
  v_mfma_f32_16x16x32_bf16 v[20:23], v[12:15], v[160:163], v[20:23]
  s_movk_i32 s96, 6
L_w92:
  s_getreg_b32 s97, hwreg(HW_REG_IB_STS, 0, 4)
  s_cmp_lt_u32 s97, 5
  s_cbranch_scc1 L_g92
  s_sub_u32 s96, s96, 1
  s_cbranch_scc0 L_w92
L_g92:
  s_waitcnt vmcnt(6)
  s_xor_b32 s68, s83, 69632
  buffer_load_dwordx4 v[192:195], v6, s[36:39], s68 offen offset:0 nt
  v_and_b32_dpp v12, v44, v8 row_newbcast:14 row_mask:0xf bank_mask:0xf
  v_and_b32_dpp v13, v44, v9 row_newbcast:14 row_mask:0xf bank_mask:0xf
  v_and_b32_dpp v14, v44, v10 row_newbcast:14 row_mask:0xf bank_mask:0xf
  v_and_b32_dpp v15, v44, v11 row_newbcast:14 row_mask:0xf bank_mask:0xf
  v_mfma_f32_16x16x32_bf16 v[20:23], v[16:19], v[164:167], v[20:23]
  s_movk_i32 s96, 6
L_w93:
  s_getreg_b32 s97, hwreg(HW_REG_IB_STS, 0, 4)
  s_cmp_lt_u32 s97, 5
  s_cbranch_scc1 L_g93
  s_sub_u32 s96, s96, 1
  s_cbranch_scc0 L_w93
L_g93:
  s_waitcnt vmcnt(6)
  buffer_load_dwordx4 v[196:199], v6, s[36:39], s68 offen offset:512 nt
  v_and_b32_dpp v16, v44, v8 row_newbcast:15 row_mask:0xf bank_mask:0xf
  v_and_b32_dpp v17, v44, v9 row_newbcast:15 row_mask:0xf bank_mask:0xf
  v_and_b32_dpp v18, v44, v10 row_newbcast:15 row_mask:0xf bank_mask:0xf
  v_and_b32_dpp v19, v44, v11 row_newbcast:15 row_mask:0xf bank_mask:0xf
  v_mfma_f32_16x16x32_bf16 v[20:23], v[12:15], v[168:171], v[20:23]
  s_movk_i32 s96, 6
L_w94:
  s_getreg_b32 s97, hwreg(HW_REG_IB_STS, 0, 4)
  s_cmp_lt_u32 s97, 5
  s_cbranch_scc1 L_g94
  s_sub_u32 s96, s96, 1
  s_cbranch_scc0 L_w94
L_g94:
  s_waitcnt vmcnt(6)
  s_xor_b32 s68, s83, 102400
  buffer_load_dwordx4 v[200:203], v6, s[36:39], s68 offen offset:0 nt
  v_and_b32_dpp v12, v45, v8 row_newbcast:0 row_mask:0xf bank_mask:0xf
  v_and_b32_dpp v13, v45, v9 row_newbcast:0 row_mask:0xf bank_mask:0xf
  v_and_b32_dpp v14, v45, v10 row_newbcast:0 row_mask:0xf bank_mask:0xf
  v_and_b32_dpp v15, v45, v11 row_newbcast:0 row_mask:0xf bank_mask:0xf
  v_mfma_f32_16x16x32_bf16 v[20:23], v[16:19], v[172:175], v[20:23]
  s_movk_i32 s96, 6
L_w95:
  s_getreg_b32 s97, hwreg(HW_REG_IB_STS, 0, 4)
  s_cmp_lt_u32 s97, 5
  s_cbranch_scc1 L_g95
  s_sub_u32 s96, s96, 1
  s_cbranch_scc0 L_w95
L_g95:
  s_waitcnt vmcnt(6)
  buffer_load_dwordx4 v[204:207], v6, s[36:39], s68 offen offset:512 nt
  v_and_b32_dpp v16, v45, v8 row_newbcast:1 row_mask:0xf bank_mask:0xf
  v_and_b32_dpp v17, v45, v9 row_newbcast:1 row_mask:0xf bank_mask:0xf
  v_and_b32_dpp v18, v45, v10 row_newbcast:1 row_mask:0xf bank_mask:0xf
  v_and_b32_dpp v19, v45, v11 row_newbcast:1 row_mask:0xf bank_mask:0xf
  v_mfma_f32_16x16x32_bf16 v[20:23], v[12:15], v[176:179], v[20:23]
  s_movk_i32 s96, 6
L_w96:
  s_getreg_b32 s97, hwreg(HW_REG_IB_STS, 0, 4)
  s_cmp_lt_u32 s97, 5
  s_cbranch_scc1 L_g96
  s_sub_u32 s96, s96, 1
  s_cbranch_scc0 L_w96
L_g96:
  s_waitcnt vmcnt(6)
  s_xor_b32 s68, s83, 20480
  buffer_load_dwordx4 v[208:211], v6, s[36:39], s68 offen offset:0 nt
  ds_write_b32 v51, v51 offset:324
  v_and_b32_dpp v12, v45, v8 row_newbcast:2 row_mask:0xf bank_mask:0xf
  v_and_b32_dpp v13, v45, v9 row_newbcast:2 row_mask:0xf bank_mask:0xf
  v_and_b32_dpp v14, v45, v10 row_newbcast:2 row_mask:0xf bank_mask:0xf
  v_and_b32_dpp v15, v45, v11 row_newbcast:2 row_mask:0xf bank_mask:0xf
  v_mfma_f32_16x16x32_bf16 v[20:23], v[16:19], v[180:183], v[20:23]
  s_movk_i32 s96, 6
L_w97:
  s_getreg_b32 s97, hwreg(HW_REG_IB_STS, 0, 4)
  s_cmp_lt_u32 s97, 5
  s_cbranch_scc1 L_g97
  s_sub_u32 s96, s96, 1
  s_cbranch_scc0 L_w97
L_g97:
  s_waitcnt vmcnt(6)
  buffer_load_dwordx4 v[212:215], v6, s[36:39], s68 offen offset:512 nt
  v_and_b32_dpp v16, v45, v8 row_newbcast:3 row_mask:0xf bank_mask:0xf
  v_and_b32_dpp v17, v45, v9 row_newbcast:3 row_mask:0xf bank_mask:0xf
  v_and_b32_dpp v18, v45, v10 row_newbcast:3 row_mask:0xf bank_mask:0xf
  v_and_b32_dpp v19, v45, v11 row_newbcast:3 row_mask:0xf bank_mask:0xf
  v_mfma_f32_16x16x32_bf16 v[20:23], v[12:15], v[184:187], v[20:23]
  s_movk_i32 s96, 6
L_w98:
  s_getreg_b32 s97, hwreg(HW_REG_IB_STS, 0, 4)
  s_cmp_lt_u32 s97, 5
  s_cbranch_scc1 L_g98
  s_sub_u32 s96, s96, 1
  s_cbranch_scc0 L_w98
L_g98:
  s_waitcnt vmcnt(6)
  s_xor_b32 s68, s83, 53248
  buffer_load_dwordx4 v[216:219], v6, s[36:39], s68 offen offset:0 nt
  v_and_b32_dpp v12, v45, v8 row_newbcast:4 row_mask:0xf bank_mask:0xf
  v_and_b32_dpp v13, v45, v9 row_newbcast:4 row_mask:0xf bank_mask:0xf
  v_and_b32_dpp v14, v45, v10 row_newbcast:4 row_mask:0xf bank_mask:0xf
  v_and_b32_dpp v15, v45, v11 row_newbcast:4 row_mask:0xf bank_mask:0xf
  v_mfma_f32_16x16x32_bf16 v[20:23], v[16:19], v[188:191], v[20:23]
  s_movk_i32 s96, 6
L_w99:
  s_getreg_b32 s97, hwreg(HW_REG_IB_STS, 0, 4)
  s_cmp_lt_u32 s97, 5
  s_cbranch_scc1 L_g99
  s_sub_u32 s96, s96, 1
  s_cbranch_scc0 L_w99
L_g99:
  s_waitcnt vmcnt(6)
  buffer_load_dwordx4 v[220:223], v6, s[36:39], s68 offen offset:512 nt
  v_and_b32_dpp v16, v45, v8 row_newbcast:5 row_mask:0xf bank_mask:0xf
  v_and_b32_dpp v17, v45, v9 row_newbcast:5 row_mask:0xf bank_mask:0xf
  v_and_b32_dpp v18, v45, v10 row_newbcast:5 row_mask:0xf bank_mask:0xf
  v_and_b32_dpp v19, v45, v11 row_newbcast:5 row_mask:0xf bank_mask:0xf
  v_mfma_f32_16x16x32_bf16 v[20:23], v[12:15], v[192:195], v[20:23]
  s_movk_i32 s96, 6
L_w100:
  s_getreg_b32 s97, hwreg(HW_REG_IB_STS, 0, 4)
  s_cmp_lt_u32 s97, 5
  s_cbranch_scc1 L_g100
  s_sub_u32 s96, s96, 1
  s_cbranch_scc0 L_w100
L_g100:
  s_waitcnt vmcnt(6)
  s_xor_b32 s68, s83, 86016
  buffer_load_dwordx4 v[224:227], v6, s[36:39], s68 offen offset:0 nt
  v_and_b32_dpp v12, v45, v8 row_newbcast:6 row_mask:0xf bank_mask:0xf
  v_and_b32_dpp v13, v45, v9 row_newbcast:6 row_mask:0xf bank_mask:0xf
  v_and_b32_dpp v14, v45, v10 row_newbcast:6 row_mask:0xf bank_mask:0xf
  v_and_b32_dpp v15, v45, v11 row_newbcast:6 row_mask:0xf bank_mask:0xf
  v_mfma_f32_16x16x32_bf16 v[20:23], v[16:19], v[196:199], v[20:23]
  s_movk_i32 s96, 6
L_w101:
  s_getreg_b32 s97, hwreg(HW_REG_IB_STS, 0, 4)
  s_cmp_lt_u32 s97, 5
  s_cbranch_scc1 L_g101
  s_sub_u32 s96, s96, 1
  s_cbranch_scc0 L_w101
L_g101:
  s_waitcnt vmcnt(6)
  buffer_load_dwordx4 v[228:231], v6, s[36:39], s68 offen offset:512 nt
  v_and_b32_dpp v16, v45, v8 row_newbcast:7 row_mask:0xf bank_mask:0xf
  v_and_b32_dpp v17, v45, v9 row_newbcast:7 row_mask:0xf bank_mask:0xf
  v_and_b32_dpp v18, v45, v10 row_newbcast:7 row_mask:0xf bank_mask:0xf
  v_and_b32_dpp v19, v45, v11 row_newbcast:7 row_mask:0xf bank_mask:0xf
  v_mfma_f32_16x16x32_bf16 v[20:23], v[12:15], v[200:203], v[20:23]
  s_movk_i32 s96, 6
L_w102:
  s_getreg_b32 s97, hwreg(HW_REG_IB_STS, 0, 4)
  s_cmp_lt_u32 s97, 5
  s_cbranch_scc1 L_g102
  s_sub_u32 s96, s96, 1
  s_cbranch_scc0 L_w102
L_g102:
  s_waitcnt vmcnt(6)
  s_xor_b32 s68, s83, 118784
  buffer_load_dwordx4 v[232:235], v6, s[36:39], s68 offen offset:0 nt
  v_and_b32_dpp v12, v45, v8 row_newbcast:8 row_mask:0xf bank_mask:0xf
  v_and_b32_dpp v13, v45, v9 row_newbcast:8 row_mask:0xf bank_mask:0xf
  v_and_b32_dpp v14, v45, v10 row_newbcast:8 row_mask:0xf bank_mask:0xf
  v_and_b32_dpp v15, v45, v11 row_newbcast:8 row_mask:0xf bank_mask:0xf
  v_mfma_f32_16x16x32_bf16 v[20:23], v[16:19], v[204:207], v[20:23]
  s_movk_i32 s96, 6
L_w103:
  s_getreg_b32 s97, hwreg(HW_REG_IB_STS, 0, 4)
  s_cmp_lt_u32 s97, 5
  s_cbranch_scc1 L_g103
  s_sub_u32 s96, s96, 1
  s_cbranch_scc0 L_w103
L_g103:
  s_waitcnt vmcnt(6)
  buffer_load_dwordx4 v[236:239], v6, s[36:39], s68 offen offset:512 nt
  v_and_b32_dpp v16, v45, v8 row_newbcast:9 row_mask:0xf bank_mask:0xf
  v_and_b32_dpp v17, v45, v9 row_newbcast:9 row_mask:0xf bank_mask:0xf
  v_and_b32_dpp v18, v45, v10 row_newbcast:9 row_mask:0xf bank_mask:0xf
  v_and_b32_dpp v19, v45, v11 row_newbcast:9 row_mask:0xf bank_mask:0xf
  v_mfma_f32_16x16x32_bf16 v[20:23], v[12:15], v[208:211], v[20:23]
  s_movk_i32 s96, 6
L_w104:
  s_getreg_b32 s97, hwreg(HW_REG_IB_STS, 0, 4)
  s_cmp_lt_u32 s97, 5
  s_cbranch_scc1 L_g104
  s_sub_u32 s96, s96, 1
  s_cbranch_scc0 L_w104
L_g104:
  s_waitcnt vmcnt(6)
  s_xor_b32 s68, s83, 131072
  buffer_load_dwordx4 v[240:243], v6, s[36:39], s68 offen offset:0 nt
  v_and_b32_dpp v12, v45, v8 row_newbcast:10 row_mask:0xf bank_mask:0xf
  v_and_b32_dpp v13, v45, v9 row_newbcast:10 row_mask:0xf bank_mask:0xf
  v_and_b32_dpp v14, v45, v10 row_newbcast:10 row_mask:0xf bank_mask:0xf
  v_and_b32_dpp v15, v45, v11 row_newbcast:10 row_mask:0xf bank_mask:0xf
  v_mfma_f32_16x16x32_bf16 v[20:23], v[16:19], v[212:215], v[20:23]
  s_movk_i32 s96, 6
L_w105:
  s_getreg_b32 s97, hwreg(HW_REG_IB_STS, 0, 4)
  s_cmp_lt_u32 s97, 5
  s_cbranch_scc1 L_g105
  s_sub_u32 s96, s96, 1
  s_cbranch_scc0 L_w105
L_g105:
  s_waitcnt vmcnt(6)
  buffer_load_dwordx4 v[244:247], v6, s[36:39], s68 offen offset:512 nt
  v_and_b32_dpp v16, v45, v8 row_newbcast:11 row_mask:0xf bank_mask:0xf
  v_and_b32_dpp v17, v45, v9 row_newbcast:11 row_mask:0xf bank_mask:0xf
  v_and_b32_dpp v18, v45, v10 row_newbcast:11 row_mask:0xf bank_mask:0xf
  v_and_b32_dpp v19, v45, v11 row_newbcast:11 row_mask:0xf bank_mask:0xf
  v_mfma_f32_16x16x32_bf16 v[20:23], v[12:15], v[216:219], v[20:23]
  s_movk_i32 s96, 6
L_w106:
  s_getreg_b32 s97, hwreg(HW_REG_IB_STS, 0, 4)
  s_cmp_lt_u32 s97, 5
  s_cbranch_scc1 L_g106
  s_sub_u32 s96, s96, 1
  s_cbranch_scc0 L_w106
L_g106:
  s_waitcnt vmcnt(6)
  s_xor_b32 s68, s83, 163840
  buffer_load_dwordx4 v[248:251], v6, s[36:39], s68 offen offset:0 nt
  v_and_b32_dpp v12, v45, v8 row_newbcast:12 row_mask:0xf bank_mask:0xf
  v_and_b32_dpp v13, v45, v9 row_newbcast:12 row_mask:0xf bank_mask:0xf
  v_and_b32_dpp v14, v45, v10 row_newbcast:12 row_mask:0xf bank_mask:0xf
  v_and_b32_dpp v15, v45, v11 row_newbcast:12 row_mask:0xf bank_mask:0xf
  v_mfma_f32_16x16x32_bf16 v[20:23], v[16:19], v[220:223], v[20:23]
  s_movk_i32 s96, 6
L_w107:
  s_getreg_b32 s97, hwreg(HW_REG_IB_STS, 0, 4)
  s_cmp_lt_u32 s97, 5
  s_cbranch_scc1 L_g107
  s_sub_u32 s96, s96, 1
  s_cbranch_scc0 L_w107
L_g107:
  s_waitcnt vmcnt(6)
  buffer_load_dwordx4 v[252:255], v6, s[36:39], s68 offen offset:512 nt
  v_and_b32_dpp v16, v45, v8 row_newbcast:13 row_mask:0xf bank_mask:0xf
  v_and_b32_dpp v17, v45, v9 row_newbcast:13 row_mask:0xf bank_mask:0xf
  v_and_b32_dpp v18, v45, v10 row_newbcast:13 row_mask:0xf bank_mask:0xf
  v_and_b32_dpp v19, v45, v11 row_newbcast:13 row_mask:0xf bank_mask:0xf
  v_mfma_f32_16x16x32_bf16 v[20:23], v[12:15], v[224:227], v[20:23]
  s_movk_i32 s96, 6
L_w108:
  s_getreg_b32 s97, hwreg(HW_REG_IB_STS, 0, 4)
  s_cmp_lt_u32 s97, 5
  s_cbranch_scc1 L_g108
  s_sub_u32 s96, s96, 1
  s_cbranch_scc0 L_w108
L_g108:
  s_waitcnt vmcnt(6)
  s_xor_b32 s68, s83, 196608
  buffer_load_dwordx4 v[56:59], v6, s[36:39], s68 offen offset:0 nt
  v_and_b32_dpp v12, v45, v8 row_newbcast:14 row_mask:0xf bank_mask:0xf
  v_and_b32_dpp v13, v45, v9 row_newbcast:14 row_mask:0xf bank_mask:0xf
  v_and_b32_dpp v14, v45, v10 row_newbcast:14 row_mask:0xf bank_mask:0xf
  v_and_b32_dpp v15, v45, v11 row_newbcast:14 row_mask:0xf bank_mask:0xf
  v_mfma_f32_16x16x32_bf16 v[20:23], v[16:19], v[228:231], v[20:23]
  s_movk_i32 s96, 6
L_w109:
  s_getreg_b32 s97, hwreg(HW_REG_IB_STS, 0, 4)
  s_cmp_lt_u32 s97, 5
  s_cbranch_scc1 L_g109
  s_sub_u32 s96, s96, 1
  s_cbranch_scc0 L_w109
L_g109:
  s_waitcnt vmcnt(6)
  buffer_load_dwordx4 v[60:63], v6, s[36:39], s68 offen offset:512 nt
  v_and_b32_dpp v16, v45, v8 row_newbcast:15 row_mask:0xf bank_mask:0xf
  v_and_b32_dpp v17, v45, v9 row_newbcast:15 row_mask:0xf bank_mask:0xf
  v_and_b32_dpp v18, v45, v10 row_newbcast:15 row_mask:0xf bank_mask:0xf
  v_and_b32_dpp v19, v45, v11 row_newbcast:15 row_mask:0xf bank_mask:0xf
  v_mfma_f32_16x16x32_bf16 v[20:23], v[12:15], v[232:235], v[20:23]
  s_movk_i32 s96, 6
L_w110:
  s_getreg_b32 s97, hwreg(HW_REG_IB_STS, 0, 4)
  s_cmp_lt_u32 s97, 5
  s_cbranch_scc1 L_g110
  s_sub_u32 s96, s96, 1
  s_cbranch_scc0 L_w110
L_g110:
  s_waitcnt vmcnt(6)
  s_xor_b32 s68, s83, 229376
  buffer_load_dwordx4 v[64:67], v6, s[36:39], s68 offen offset:0 nt
  v_and_b32_dpp v12, v46, v8 row_newbcast:0 row_mask:0xf bank_mask:0xf
  v_and_b32_dpp v13, v46, v9 row_newbcast:0 row_mask:0xf bank_mask:0xf
  v_and_b32_dpp v14, v46, v10 row_newbcast:0 row_mask:0xf bank_mask:0xf
  v_and_b32_dpp v15, v46, v11 row_newbcast:0 row_mask:0xf bank_mask:0xf
  v_mfma_f32_16x16x32_bf16 v[20:23], v[16:19], v[236:239], v[20:23]
  s_movk_i32 s96, 6
L_w111:
  s_getreg_b32 s97, hwreg(HW_REG_IB_STS, 0, 4)
  s_cmp_lt_u32 s97, 5
  s_cbranch_scc1 L_g111
  s_sub_u32 s96, s96, 1
  s_cbranch_scc0 L_w111
L_g111:
  s_waitcnt vmcnt(6)
  buffer_load_dwordx4 v[68:71], v6, s[36:39], s68 offen offset:512 nt
  v_and_b32_dpp v16, v46, v8 row_newbcast:1 row_mask:0xf bank_mask:0xf
  v_and_b32_dpp v17, v46, v9 row_newbcast:1 row_mask:0xf bank_mask:0xf
  v_and_b32_dpp v18, v46, v10 row_newbcast:1 row_mask:0xf bank_mask:0xf
  v_and_b32_dpp v19, v46, v11 row_newbcast:1 row_mask:0xf bank_mask:0xf
  v_mfma_f32_16x16x32_bf16 v[20:23], v[12:15], v[240:243], v[20:23]
  s_movk_i32 s96, 6
L_w112:
  s_getreg_b32 s97, hwreg(HW_REG_IB_STS, 0, 4)
  s_cmp_lt_u32 s97, 5
  s_cbranch_scc1 L_g112
  s_sub_u32 s96, s96, 1
  s_cbranch_scc0 L_w112
L_g112:
  s_waitcnt vmcnt(6)
  s_xor_b32 s68, s83, 147456
  buffer_load_dwordx4 v[72:75], v6, s[36:39], s68 offen offset:0 nt
  v_and_b32_dpp v12, v46, v8 row_newbcast:2 row_mask:0xf bank_mask:0xf
  v_and_b32_dpp v13, v46, v9 row_newbcast:2 row_mask:0xf bank_mask:0xf
  v_and_b32_dpp v14, v46, v10 row_newbcast:2 row_mask:0xf bank_mask:0xf
  v_and_b32_dpp v15, v46, v11 row_newbcast:2 row_mask:0xf bank_mask:0xf
  v_mfma_f32_16x16x32_bf16 v[20:23], v[16:19], v[244:247], v[20:23]
  s_movk_i32 s96, 6
L_w113:
  s_getreg_b32 s97, hwreg(HW_REG_IB_STS, 0, 4)
  s_cmp_lt_u32 s97, 5
  s_cbranch_scc1 L_g113
  s_sub_u32 s96, s96, 1
  s_cbranch_scc0 L_w113
L_g113:
  s_waitcnt vmcnt(6)
  buffer_load_dwordx4 v[76:79], v6, s[36:39], s68 offen offset:512 nt
  v_and_b32_dpp v16, v46, v8 row_newbcast:3 row_mask:0xf bank_mask:0xf
  v_and_b32_dpp v17, v46, v9 row_newbcast:3 row_mask:0xf bank_mask:0xf
  v_and_b32_dpp v18, v46, v10 row_newbcast:3 row_mask:0xf bank_mask:0xf
  v_and_b32_dpp v19, v46, v11 row_newbcast:3 row_mask:0xf bank_mask:0xf
  v_mfma_f32_16x16x32_bf16 v[20:23], v[12:15], v[248:251], v[20:23]
  s_movk_i32 s96, 6
L_w114:
  s_getreg_b32 s97, hwreg(HW_REG_IB_STS, 0, 4)
  s_cmp_lt_u32 s97, 5
  s_cbranch_scc1 L_g114
  s_sub_u32 s96, s96, 1
  s_cbranch_scc0 L_w114
L_g114:
  s_waitcnt vmcnt(6)
  s_xor_b32 s68, s83, 180224
  buffer_load_dwordx4 v[80:83], v6, s[36:39], s68 offen offset:0 nt
  v_and_b32_dpp v12, v46, v8 row_newbcast:4 row_mask:0xf bank_mask:0xf
  v_and_b32_dpp v13, v46, v9 row_newbcast:4 row_mask:0xf bank_mask:0xf
  v_and_b32_dpp v14, v46, v10 row_newbcast:4 row_mask:0xf bank_mask:0xf
  v_and_b32_dpp v15, v46, v11 row_newbcast:4 row_mask:0xf bank_mask:0xf
  v_mfma_f32_16x16x32_bf16 v[20:23], v[16:19], v[252:255], v[20:23]
  s_movk_i32 s96, 6
L_w115:
  s_getreg_b32 s97, hwreg(HW_REG_IB_STS, 0, 4)
  s_cmp_lt_u32 s97, 5
  s_cbranch_scc1 L_g115
  s_sub_u32 s96, s96, 1
  s_cbranch_scc0 L_w115
L_g115:
  s_waitcnt vmcnt(6)
  buffer_load_dwordx4 v[84:87], v6, s[36:39], s68 offen offset:512 nt
  v_and_b32_dpp v16, v46, v8 row_newbcast:5 row_mask:0xf bank_mask:0xf
  v_and_b32_dpp v17, v46, v9 row_newbcast:5 row_mask:0xf bank_mask:0xf
  v_and_b32_dpp v18, v46, v10 row_newbcast:5 row_mask:0xf bank_mask:0xf
  v_and_b32_dpp v19, v46, v11 row_newbcast:5 row_mask:0xf bank_mask:0xf
  v_mfma_f32_16x16x32_bf16 v[20:23], v[12:15], v[56:59], v[20:23]
  s_movk_i32 s96, 6
L_w116:
  s_getreg_b32 s97, hwreg(HW_REG_IB_STS, 0, 4)
  s_cmp_lt_u32 s97, 5
  s_cbranch_scc1 L_g116
  s_sub_u32 s96, s96, 1
  s_cbranch_scc0 L_w116
L_g116:
  s_waitcnt vmcnt(6)
  s_xor_b32 s68, s83, 212992
  buffer_load_dwordx4 v[88:91], v6, s[36:39], s68 offen offset:0 nt
  v_and_b32_dpp v12, v46, v8 row_newbcast:6 row_mask:0xf bank_mask:0xf
  v_and_b32_dpp v13, v46, v9 row_newbcast:6 row_mask:0xf bank_mask:0xf
  v_and_b32_dpp v14, v46, v10 row_newbcast:6 row_mask:0xf bank_mask:0xf
  v_and_b32_dpp v15, v46, v11 row_newbcast:6 row_mask:0xf bank_mask:0xf
  v_mfma_f32_16x16x32_bf16 v[20:23], v[16:19], v[60:63], v[20:23]
  s_movk_i32 s96, 6
L_w117:
  s_getreg_b32 s97, hwreg(HW_REG_IB_STS, 0, 4)
  s_cmp_lt_u32 s97, 5
  s_cbranch_scc1 L_g117
  s_sub_u32 s96, s96, 1
  s_cbranch_scc0 L_w117
L_g117:
  s_waitcnt vmcnt(6)
  buffer_load_dwordx4 v[92:95], v6, s[36:39], s68 offen offset:512 nt
  v_and_b32_dpp v16, v46, v8 row_newbcast:7 row_mask:0xf bank_mask:0xf
  v_and_b32_dpp v17, v46, v9 row_newbcast:7 row_mask:0xf bank_mask:0xf
  v_and_b32_dpp v18, v46, v10 row_newbcast:7 row_mask:0xf bank_mask:0xf
  v_and_b32_dpp v19, v46, v11 row_newbcast:7 row_mask:0xf bank_mask:0xf
  v_mfma_f32_16x16x32_bf16 v[20:23], v[12:15], v[64:67], v[20:23]
  s_movk_i32 s96, 6
L_w118:
  s_getreg_b32 s97, hwreg(HW_REG_IB_STS, 0, 4)
  s_cmp_lt_u32 s97, 5
  s_cbranch_scc1 L_g118
  s_sub_u32 s96, s96, 1
  s_cbranch_scc0 L_w118
L_g118:
  s_waitcnt vmcnt(6)
  s_xor_b32 s68, s83, 245760
  buffer_load_dwordx4 v[96:99], v6, s[36:39], s68 offen offset:0 nt
  v_and_b32_dpp v12, v46, v8 row_newbcast:8 row_mask:0xf bank_mask:0xf
  v_and_b32_dpp v13, v46, v9 row_newbcast:8 row_mask:0xf bank_mask:0xf
  v_and_b32_dpp v14, v46, v10 row_newbcast:8 row_mask:0xf bank_mask:0xf
  v_and_b32_dpp v15, v46, v11 row_newbcast:8 row_mask:0xf bank_mask:0xf
  v_mfma_f32_16x16x32_bf16 v[20:23], v[16:19], v[68:71], v[20:23]
  s_movk_i32 s96, 6
L_w119:
  s_getreg_b32 s97, hwreg(HW_REG_IB_STS, 0, 4)
  s_cmp_lt_u32 s97, 5
  s_cbranch_scc1 L_g119
  s_sub_u32 s96, s96, 1
  s_cbranch_scc0 L_w119
L_g119:
  s_waitcnt vmcnt(6)
  buffer_load_dwordx4 v[100:103], v6, s[36:39], s68 offen offset:512 nt
  v_and_b32_dpp v16, v46, v8 row_newbcast:9 row_mask:0xf bank_mask:0xf
  v_and_b32_dpp v17, v46, v9 row_newbcast:9 row_mask:0xf bank_mask:0xf
  v_and_b32_dpp v18, v46, v10 row_newbcast:9 row_mask:0xf bank_mask:0xf
  v_and_b32_dpp v19, v46, v11 row_newbcast:9 row_mask:0xf bank_mask:0xf
  v_mfma_f32_16x16x32_bf16 v[20:23], v[12:15], v[72:75], v[20:23]
  s_movk_i32 s96, 6
L_w120:
  s_getreg_b32 s97, hwreg(HW_REG_IB_STS, 0, 4)
  s_cmp_lt_u32 s97, 5
  s_cbranch_scc1 L_g120
  s_sub_u32 s96, s96, 1
  s_cbranch_scc0 L_w120
L_g120:
  s_waitcnt vmcnt(6)
  s_xor_b32 s68, s83, 135168
  buffer_load_dwordx4 v[104:107], v6, s[36:39], s68 offen offset:0 nt
  v_and_b32_dpp v12, v46, v8 row_newbcast:10 row_mask:0xf bank_mask:0xf
  v_and_b32_dpp v13, v46, v9 row_newbcast:10 row_mask:0xf bank_mask:0xf
  v_and_b32_dpp v14, v46, v10 row_newbcast:10 row_mask:0xf bank_mask:0xf
  v_and_b32_dpp v15, v46, v11 row_newbcast:10 row_mask:0xf bank_mask:0xf
  v_mfma_f32_16x16x32_bf16 v[20:23], v[16:19], v[76:79], v[20:23]
  s_movk_i32 s96, 6
L_w121:
  s_getreg_b32 s97, hwreg(HW_REG_IB_STS, 0, 4)
  s_cmp_lt_u32 s97, 5
  s_cbranch_scc1 L_g121
  s_sub_u32 s96, s96, 1
  s_cbranch_scc0 L_w121
L_g121:
  s_waitcnt vmcnt(6)
  buffer_load_dwordx4 v[108:111], v6, s[36:39], s68 offen offset:512 nt
  v_and_b32_dpp v16, v46, v8 row_newbcast:11 row_mask:0xf bank_mask:0xf
  v_and_b32_dpp v17, v46, v9 row_newbcast:11 row_mask:0xf bank_mask:0xf
  v_and_b32_dpp v18, v46, v10 row_newbcast:11 row_mask:0xf bank_mask:0xf
  v_and_b32_dpp v19, v46, v11 row_newbcast:11 row_mask:0xf bank_mask:0xf
  v_mfma_f32_16x16x32_bf16 v[20:23], v[12:15], v[80:83], v[20:23]
  s_movk_i32 s96, 6
L_w122:
  s_getreg_b32 s97, hwreg(HW_REG_IB_STS, 0, 4)
  s_cmp_lt_u32 s97, 5
  s_cbranch_scc1 L_g122
  s_sub_u32 s96, s96, 1
  s_cbranch_scc0 L_w122
L_g122:
  s_waitcnt vmcnt(6)
  s_xor_b32 s68, s83, 167936
  buffer_load_dwordx4 v[112:115], v6, s[36:39], s68 offen offset:0 nt
  v_and_b32_dpp v12, v46, v8 row_newbcast:12 row_mask:0xf bank_mask:0xf
  v_and_b32_dpp v13, v46, v9 row_newbcast:12 row_mask:0xf bank_mask:0xf
  v_and_b32_dpp v14, v46, v10 row_newbcast:12 row_mask:0xf bank_mask:0xf
  v_and_b32_dpp v15, v46, v11 row_newbcast:12 row_mask:0xf bank_mask:0xf
  v_mfma_f32_16x16x32_bf16 v[20:23], v[16:19], v[84:87], v[20:23]
  s_movk_i32 s96, 6
L_w123:
  s_getreg_b32 s97, hwreg(HW_REG_IB_STS, 0, 4)
  s_cmp_lt_u32 s97, 5
  s_cbranch_scc1 L_g123
  s_sub_u32 s96, s96, 1
  s_cbranch_scc0 L_w123
L_g123:
  s_waitcnt vmcnt(6)
  buffer_load_dwordx4 v[116:119], v6, s[36:39], s68 offen offset:512 nt
  v_and_b32_dpp v16, v46, v8 row_newbcast:13 row_mask:0xf bank_mask:0xf
  v_and_b32_dpp v17, v46, v9 row_newbcast:13 row_mask:0xf bank_mask:0xf
  v_and_b32_dpp v18, v46, v10 row_newbcast:13 row_mask:0xf bank_mask:0xf
  v_and_b32_dpp v19, v46, v11 row_newbcast:13 row_mask:0xf bank_mask:0xf
  v_mfma_f32_16x16x32_bf16 v[20:23], v[12:15], v[88:91], v[20:23]
  s_movk_i32 s96, 6
L_w124:
  s_getreg_b32 s97, hwreg(HW_REG_IB_STS, 0, 4)
  s_cmp_lt_u32 s97, 5
  s_cbranch_scc1 L_g124
  s_sub_u32 s96, s96, 1
  s_cbranch_scc0 L_w124
L_g124:
  s_waitcnt vmcnt(6)
  s_xor_b32 s68, s83, 200704
  buffer_load_dwordx4 v[120:123], v6, s[36:39], s68 offen offset:0 nt
  v_and_b32_dpp v12, v46, v8 row_newbcast:14 row_mask:0xf bank_mask:0xf
  v_and_b32_dpp v13, v46, v9 row_newbcast:14 row_mask:0xf bank_mask:0xf
  v_and_b32_dpp v14, v46, v10 row_newbcast:14 row_mask:0xf bank_mask:0xf
  v_and_b32_dpp v15, v46, v11 row_newbcast:14 row_mask:0xf bank_mask:0xf
  v_mfma_f32_16x16x32_bf16 v[20:23], v[16:19], v[92:95], v[20:23]
  s_movk_i32 s96, 6
L_w125:
  s_getreg_b32 s97, hwreg(HW_REG_IB_STS, 0, 4)
  s_cmp_lt_u32 s97, 5
  s_cbranch_scc1 L_g125
  s_sub_u32 s96, s96, 1
  s_cbranch_scc0 L_w125
L_g125:
  s_waitcnt vmcnt(6)
  buffer_load_dwordx4 v[124:127], v6, s[36:39], s68 offen offset:512 nt
  v_and_b32_dpp v16, v46, v8 row_newbcast:15 row_mask:0xf bank_mask:0xf
  v_and_b32_dpp v17, v46, v9 row_newbcast:15 row_mask:0xf bank_mask:0xf
  v_and_b32_dpp v18, v46, v10 row_newbcast:15 row_mask:0xf bank_mask:0xf
  v_and_b32_dpp v19, v46, v11 row_newbcast:15 row_mask:0xf bank_mask:0xf
  v_mfma_f32_16x16x32_bf16 v[20:23], v[12:15], v[96:99], v[20:23]
  s_movk_i32 s96, 6
L_w126:
  s_getreg_b32 s97, hwreg(HW_REG_IB_STS, 0, 4)
  s_cmp_lt_u32 s97, 5
  s_cbranch_scc1 L_g126
  s_sub_u32 s96, s96, 1
  s_cbranch_scc0 L_w126
L_g126:
  s_waitcnt vmcnt(6)
  s_xor_b32 s68, s83, 233472
  buffer_load_dwordx4 v[128:131], v6, s[36:39], s68 offen offset:0 nt
  v_and_b32_dpp v12, v47, v8 row_newbcast:0 row_mask:0xf bank_mask:0xf
  v_and_b32_dpp v13, v47, v9 row_newbcast:0 row_mask:0xf bank_mask:0xf
  v_and_b32_dpp v14, v47, v10 row_newbcast:0 row_mask:0xf bank_mask:0xf
  v_and_b32_dpp v15, v47, v11 row_newbcast:0 row_mask:0xf bank_mask:0xf
  v_mfma_f32_16x16x32_bf16 v[20:23], v[16:19], v[100:103], v[20:23]
  s_movk_i32 s96, 6
L_w127:
  s_getreg_b32 s97, hwreg(HW_REG_IB_STS, 0, 4)
  s_cmp_lt_u32 s97, 5
  s_cbranch_scc1 L_g127
  s_sub_u32 s96, s96, 1
  s_cbranch_scc0 L_w127
L_g127:
  s_waitcnt vmcnt(6)
  buffer_load_dwordx4 v[132:135], v6, s[36:39], s68 offen offset:512 nt
  v_and_b32_dpp v16, v47, v8 row_newbcast:1 row_mask:0xf bank_mask:0xf
  v_and_b32_dpp v17, v47, v9 row_newbcast:1 row_mask:0xf bank_mask:0xf
  v_and_b32_dpp v18, v47, v10 row_newbcast:1 row_mask:0xf bank_mask:0xf
  v_and_b32_dpp v19, v47, v11 row_newbcast:1 row_mask:0xf bank_mask:0xf
  v_mfma_f32_16x16x32_bf16 v[20:23], v[12:15], v[104:107], v[20:23]
  s_movk_i32 s96, 6
L_w128:
  s_getreg_b32 s97, hwreg(HW_REG_IB_STS, 0, 4)
  s_cmp_lt_u32 s97, 5
  s_cbranch_scc1 L_g128
  s_sub_u32 s96, s96, 1
  s_cbranch_scc0 L_w128
L_g128:
  s_waitcnt vmcnt(6)
  s_xor_b32 s68, s83, 151552
  buffer_load_dwordx4 v[136:139], v6, s[36:39], s68 offen offset:0 nt
  v_and_b32_dpp v12, v47, v8 row_newbcast:2 row_mask:0xf bank_mask:0xf
  v_and_b32_dpp v13, v47, v9 row_newbcast:2 row_mask:0xf bank_mask:0xf
  v_and_b32_dpp v14, v47, v10 row_newbcast:2 row_mask:0xf bank_mask:0xf
  v_and_b32_dpp v15, v47, v11 row_newbcast:2 row_mask:0xf bank_mask:0xf
  v_mfma_f32_16x16x32_bf16 v[20:23], v[16:19], v[108:111], v[20:23]
  s_movk_i32 s96, 6
L_w129:
  s_getreg_b32 s97, hwreg(HW_REG_IB_STS, 0, 4)
  s_cmp_lt_u32 s97, 5
  s_cbranch_scc1 L_g129
  s_sub_u32 s96, s96, 1
  s_cbranch_scc0 L_w129
L_g129:
  s_waitcnt vmcnt(6)
  buffer_load_dwordx4 v[140:143], v6, s[36:39], s68 offen offset:512 nt
  v_and_b32_dpp v16, v47, v8 row_newbcast:3 row_mask:0xf bank_mask:0xf
  v_and_b32_dpp v17, v47, v9 row_newbcast:3 row_mask:0xf bank_mask:0xf
  v_and_b32_dpp v18, v47, v10 row_newbcast:3 row_mask:0xf bank_mask:0xf
  v_and_b32_dpp v19, v47, v11 row_newbcast:3 row_mask:0xf bank_mask:0xf
  v_mfma_f32_16x16x32_bf16 v[20:23], v[12:15], v[112:115], v[20:23]
  s_movk_i32 s96, 6
L_w130:
  s_getreg_b32 s97, hwreg(HW_REG_IB_STS, 0, 4)
  s_cmp_lt_u32 s97, 5
  s_cbranch_scc1 L_g130
  s_sub_u32 s96, s96, 1
  s_cbranch_scc0 L_w130
L_g130:
  s_waitcnt vmcnt(6)
  s_xor_b32 s68, s83, 184320
  buffer_load_dwordx4 v[144:147], v6, s[36:39], s68 offen offset:0 nt
  v_and_b32_dpp v12, v47, v8 row_newbcast:4 row_mask:0xf bank_mask:0xf
  v_and_b32_dpp v13, v47, v9 row_newbcast:4 row_mask:0xf bank_mask:0xf
  v_and_b32_dpp v14, v47, v10 row_newbcast:4 row_mask:0xf bank_mask:0xf
  v_and_b32_dpp v15, v47, v11 row_newbcast:4 row_mask:0xf bank_mask:0xf
  v_mfma_f32_16x16x32_bf16 v[20:23], v[16:19], v[116:119], v[20:23]
  s_movk_i32 s96, 6
L_w131:
  s_getreg_b32 s97, hwreg(HW_REG_IB_STS, 0, 4)
  s_cmp_lt_u32 s97, 5
  s_cbranch_scc1 L_g131
  s_sub_u32 s96, s96, 1
  s_cbranch_scc0 L_w131
L_g131:
  s_waitcnt vmcnt(6)
  buffer_load_dwordx4 v[148:151], v6, s[36:39], s68 offen offset:512 nt
  v_and_b32_dpp v16, v47, v8 row_newbcast:5 row_mask:0xf bank_mask:0xf
  v_and_b32_dpp v17, v47, v9 row_newbcast:5 row_mask:0xf bank_mask:0xf
  v_and_b32_dpp v18, v47, v10 row_newbcast:5 row_mask:0xf bank_mask:0xf
  v_and_b32_dpp v19, v47, v11 row_newbcast:5 row_mask:0xf bank_mask:0xf
  v_mfma_f32_16x16x32_bf16 v[20:23], v[12:15], v[120:123], v[20:23]
  s_movk_i32 s96, 6
L_w132:
  s_getreg_b32 s97, hwreg(HW_REG_IB_STS, 0, 4)
  s_cmp_lt_u32 s97, 5
  s_cbranch_scc1 L_g132
  s_sub_u32 s96, s96, 1
  s_cbranch_scc0 L_w132
L_g132:
  s_waitcnt vmcnt(6)
  s_xor_b32 s68, s83, 217088
  buffer_load_dwordx4 v[152:155], v6, s[36:39], s68 offen offset:0 nt
  v_and_b32_dpp v12, v47, v8 row_newbcast:6 row_mask:0xf bank_mask:0xf
  v_and_b32_dpp v13, v47, v9 row_newbcast:6 row_mask:0xf bank_mask:0xf
  v_and_b32_dpp v14, v47, v10 row_newbcast:6 row_mask:0xf bank_mask:0xf
  v_and_b32_dpp v15, v47, v11 row_newbcast:6 row_mask:0xf bank_mask:0xf
  v_mfma_f32_16x16x32_bf16 v[20:23], v[16:19], v[124:127], v[20:23]
  s_waitcnt vmcnt(6)
  buffer_load_dwordx4 v[156:159], v6, s[36:39], s68 offen offset:512 nt
  v_and_b32_dpp v16, v47, v8 row_newbcast:7 row_mask:0xf bank_mask:0xf
  v_and_b32_dpp v17, v47, v9 row_newbcast:7 row_mask:0xf bank_mask:0xf
  v_and_b32_dpp v18, v47, v10 row_newbcast:7 row_mask:0xf bank_mask:0xf
  v_and_b32_dpp v19, v47, v11 row_newbcast:7 row_mask:0xf bank_mask:0xf
  v_mfma_f32_16x16x32_bf16 v[20:23], v[12:15], v[128:131], v[20:23]
  s_waitcnt vmcnt(6)
  s_xor_b32 s68, s83, 249856
  buffer_load_dwordx4 v[160:163], v6, s[36:39], s68 offen offset:0 nt
  v_and_b32_dpp v12, v47, v8 row_newbcast:8 row_mask:0xf bank_mask:0xf
  v_and_b32_dpp v13, v47, v9 row_newbcast:8 row_mask:0xf bank_mask:0xf
  v_and_b32_dpp v14, v47, v10 row_newbcast:8 row_mask:0xf bank_mask:0xf
  v_and_b32_dpp v15, v47, v11 row_newbcast:8 row_mask:0xf bank_mask:0xf
  v_mfma_f32_16x16x32_bf16 v[20:23], v[16:19], v[132:135], v[20:23]
  s_waitcnt vmcnt(6)
  buffer_load_dwordx4 v[164:167], v6, s[36:39], s68 offen offset:512 nt
  v_and_b32_dpp v16, v47, v8 row_newbcast:9 row_mask:0xf bank_mask:0xf
  v_and_b32_dpp v17, v47, v9 row_newbcast:9 row_mask:0xf bank_mask:0xf
  v_and_b32_dpp v18, v47, v10 row_newbcast:9 row_mask:0xf bank_mask:0xf
  v_and_b32_dpp v19, v47, v11 row_newbcast:9 row_mask:0xf bank_mask:0xf
  v_mfma_f32_16x16x32_bf16 v[20:23], v[12:15], v[136:139], v[20:23]
  v_and_b32_dpp v12, v47, v8 row_newbcast:10 row_mask:0xf bank_mask:0xf
  v_and_b32_dpp v13, v47, v9 row_newbcast:10 row_mask:0xf bank_mask:0xf
  v_and_b32_dpp v14, v47, v10 row_newbcast:10 row_mask:0xf bank_mask:0xf
  v_and_b32_dpp v15, v47, v11 row_newbcast:10 row_mask:0xf bank_mask:0xf
  s_waitcnt vmcnt(6)
  v_mfma_f32_16x16x32_bf16 v[20:23], v[16:19], v[140:143], v[20:23]
  v_and_b32_dpp v16, v47, v8 row_newbcast:11 row_mask:0xf bank_mask:0xf
  v_and_b32_dpp v17, v47, v9 row_newbcast:11 row_mask:0xf bank_mask:0xf
  v_and_b32_dpp v18, v47, v10 row_newbcast:11 row_mask:0xf bank_mask:0xf
  v_and_b32_dpp v19, v47, v11 row_newbcast:11 row_mask:0xf bank_mask:0xf
  s_waitcnt vmcnt(5)
  v_mfma_f32_16x16x32_bf16 v[20:23], v[12:15], v[144:147], v[20:23]
  v_and_b32_dpp v12, v47, v8 row_newbcast:12 row_mask:0xf bank_mask:0xf
  v_and_b32_dpp v13, v47, v9 row_newbcast:12 row_mask:0xf bank_mask:0xf
  v_and_b32_dpp v14, v47, v10 row_newbcast:12 row_mask:0xf bank_mask:0xf
  v_and_b32_dpp v15, v47, v11 row_newbcast:12 row_mask:0xf bank_mask:0xf
  s_waitcnt vmcnt(4)
  v_mfma_f32_16x16x32_bf16 v[20:23], v[16:19], v[148:151], v[20:23]
  ds_write_b32 v50, v51 offset:336
  v_and_b32_dpp v16, v47, v8 row_newbcast:13 row_mask:0xf bank_mask:0xf
  v_and_b32_dpp v17, v47, v9 row_newbcast:13 row_mask:0xf bank_mask:0xf
  v_and_b32_dpp v18, v47, v10 row_newbcast:13 row_mask:0xf bank_mask:0xf
  v_and_b32_dpp v19, v47, v11 row_newbcast:13 row_mask:0xf bank_mask:0xf
  s_waitcnt vmcnt(3)
  v_mfma_f32_16x16x32_bf16 v[20:23], v[12:15], v[152:155], v[20:23]
  v_and_b32_dpp v12, v47, v8 row_newbcast:14 row_mask:0xf bank_mask:0xf
  v_and_b32_dpp v13, v47, v9 row_newbcast:14 row_mask:0xf bank_mask:0xf
  v_and_b32_dpp v14, v47, v10 row_newbcast:14 row_mask:0xf bank_mask:0xf
  v_and_b32_dpp v15, v47, v11 row_newbcast:14 row_mask:0xf bank_mask:0xf
  s_waitcnt vmcnt(2)
  v_mfma_f32_16x16x32_bf16 v[20:23], v[16:19], v[156:159], v[20:23]
  v_and_b32_dpp v16, v47, v8 row_newbcast:15 row_mask:0xf bank_mask:0xf
  v_and_b32_dpp v17, v47, v9 row_newbcast:15 row_mask:0xf bank_mask:0xf
  v_and_b32_dpp v18, v47, v10 row_newbcast:15 row_mask:0xf bank_mask:0xf
  v_and_b32_dpp v19, v47, v11 row_newbcast:15 row_mask:0xf bank_mask:0xf
  s_waitcnt vmcnt(1)
  v_mfma_f32_16x16x32_bf16 v[20:23], v[12:15], v[160:163], v[20:23]
  s_waitcnt vmcnt(0)
  v_mfma_f32_16x16x32_bf16 v[20:23], v[16:19], v[164:167], v[20:23]
  s_mov_b32 exec_hi, 0
  s_nop 6
  ds_write_b128 v4, v[20:23] offset:1024
  s_mov_b32 exec_lo, 1
  ds_add_rtn_u32 v48, v51, v54 offset:332
  s_mov_b32 exec_lo, -1
  ds_read_b128 v[28:31], v5 offset:1024
  ds_read_b128 v[32:35], v5 offset:1536
  ds_read_b128 v[36:39], v5 offset:2048
  ds_read_b128 v[40:43], v5 offset:2560
  s_waitcnt lgkmcnt(4)
  v_readfirstlane_b32 s74, v48
  s_waitcnt lgkmcnt(2)
  v_pk_add_f32 v[28:29], v[28:29], v[32:33]
  v_pk_add_f32 v[30:31], v[30:31], v[34:35]
  s_cmp_lg_u32 s74, 2
  s_cbranch_scc1 L_end
  s_waitcnt lgkmcnt(0)
  v_pk_add_f32 v[36:37], v[36:37], v[40:41]
  v_pk_add_f32 v[38:39], v[38:39], v[42:43]
  v_pk_add_f32 v[28:29], v[28:29], v[36:37]
  v_pk_add_f32 v[30:31], v[30:31], v[38:39]
  v_cvt_pk_bf16_f32 v24, v28, v29
  v_cvt_pk_bf16_f32 v25, v30, v31
  buffer_store_dwordx4 v[24:27], v1, s[60:63], s70 offen sc1
  buffer_store_dwordx4 v[24:27], v1, s[60:63], s71 offen
  s_endpgm
L_wrole:
  s_load_dwordx8 s[20:27], s[0:1], 64
  s_load_dwordx2 s[28:29], s[0:1], 96
  v_lshlrev_b32 v2, 4, v0
  v_mov_b32 v4, -1
  v_mov_b32 v5, -1
  v_mov_b32 v6, -1
  v_mov_b32 v7, -1
  ds_write_b128 v2, v[4:7]
  v_and_b32 v0, 63, v0
  v_lshlrev_b32 v1, 4, v0
  s_lshr_b32 s3, s3, 6
  s_and_b32 s30, s2, 31
  s_lshr_b32 s31, s2, 5
  s_mov_b32 s79, 2097152
  s_sub_u32 s77, s3, 4
  s_and_b32 s90, s2, 7
  s_lshr_b32 s91, s2, 3
  s_getpc_b64 s[48:49]
L_pc:
  s_sub_u32 s48, s48, L_pc-gated_mix__sliding_block_cached__glu_gated_swiglu__decode_kernel
  s_subb_u32 s49, s49, 0
  s_mov_b32 s50, L_last-gated_mix__sliding_block_cached__glu_gated_swiglu__decode_kernel
  s_mov_b32 s51, 0x20000
  s_lshl_b32 s74, s91, 2
  s_add_u32 s74, s74, s77
  s_lshl_b32 s74, s74, 7
  v_mov_b32 v11, 0
  buffer_load_dword v3, v11, s[48:51], s74 offen
  s_lshl_b32 s69, s90, 8
  s_add_u32 s69, s69, 0x1000
  s_lshr_b32 s71, s30, 3
  s_lshl_b32 s71, s71, 6
  s_add_u32 s71, s71, s69
  s_lshl_b32 s70, s31, 3
  s_add_u32 s70, s70, s71
  s_waitcnt lgkmcnt(0)
  s_load_dwordx2 s[84:85], s[28:29], 0
  s_mov_b32 s60, s28
  s_mov_b32 s61, s29
  s_mov_b32 s62, 2097152
  s_mov_b32 s63, 0x20000
  s_getreg_b32 s74, hwreg(HW_REG_XCC_ID, 0, 4)
  v_lshrrev_b32 v12, 4, v0
  v_and_b32 v13, 15, v0
  v_and_b32 v15, 7, v0
  s_waitcnt lgkmcnt(0)
  s_add_u32 s84, s84, 0x7f4a7c15
  s_addc_u32 s85, s85, 0x9e3779b9
  s_cmp_lg_u32 s77, 2
  s_cbranch_scc1 L_nohello
  s_xor_b32 s86, s84, s74
  s_mov_b32 s87, s85
  v_mov_b32 v18, s86
  v_mov_b32 v19, s87
  s_mov_b64 exec, 1
  buffer_store_dwordx2 v[18:19], v11, s[60:63], s70 offen
  s_mov_b64 exec, -1
L_nohello:
  s_barrier
  s_lshl_b32 s78, s90, 5
  s_add_u32 s78, s78, s91
  s_lshl_b32 s78, s78, 12
  s_add_u32 s78, s78, 0x100000
  s_and_b32 s72, s91, 7
  s_mul_i32 s72, s72, 43
  s_add_u32 s73, s72, 43
  s_lshr_b32 s72, s72, 3
  s_lshr_b32 s73, s73, 3
  s_sub_u32 s73, s73, s72
  s_lshl_b32 s72, s72, 2
  s_lshr_b32 s75, s91, 3
  s_mul_i32 s75, s75, s73
  s_add_u32 s72, s72, s75
  s_lshl_b32 s74, s91, 17
  s_lshl_b32 s75, s90, 7
  s_add_u32 s74, s74, s75
  s_add_u32 s52, s12, s74
  s_addc_u32 s53, s13, 0
  s_sub_u32 s54, 0x20000, s75
  s_mov_b32 s55, 0x20000
  s_lshl_b32 s74, s72, 13
  s_add_u32 s74, s74, s75
  s_lshl_b32 s73, s73, 13
  s_add_u32 s56, s20, s74
  s_addc_u32 s57, s21, 0
  s_sub_u32 s58, s73, s75
  s_mov_b32 s59, 0x20000
  s_mov_b32 s64, s24
  s_mov_b32 s65, s25
  s_mov_b32 s66, 8192
  s_mov_b32 s67, 0x20000
  s_mov_b32 s44, s4
  s_mov_b32 s45, s5
  s_mov_b32 s46, 8192
  s_mov_b32 s47, 0x20000
  s_mov_b32 s40, s22
  s_mov_b32 s41, s23
  s_mov_b32 s42, 1024
  s_mov_b32 s43, 0x20000
  v_bfe_u32 v14, v0, 2, 2
  v_lshlrev_b32 v9, 7, v14
  v_lshl_or_b32 v9, v12, 10, v9
  v_and_b32 v14, 3, v0
  v_lshl_or_b32 v9, v14, 3, v9
  v_mov_b32 v102, s84
  v_mov_b32 v103, s85
  s_cmp_ge_u32 s77, 2
  s_cbranch_scc1 L_wlate
  s_lshr_b32 s81, s31, 1
  s_lshl_b32 s81, s81, 8
  v_lshlrev_b32 v16, 10, v15
  v_lshl_or_b32 v16, v12, 4, v16
  buffer_load_dwordx4 v[36:39], v16, s[44:47], s81 offen offset:0
  buffer_load_dwordx4 v[40:43], v16, s[44:47], s81 offen offset:64
  buffer_load_dwordx4 v[44:47], v16, s[44:47], s81 offen offset:128
  buffer_load_dwordx4 v[48:51], v16, s[44:47], s81 offen offset:192
  s_lshl_b32 s75, s77, 14
  v_add_u32 v17, s75, v9
  v_lshlrev_b32 v10, 8, v15
  v_lshl_or_b32 v10, v12, 4, v10
  v_and_b32 v14, 8, v0
  v_lshl_or_b32 v10, v14, 3, v10
  s_lshl_b32 s75, s77, 4
  v_and_or_b32 v18, v0, 12, s75
  s_waitcnt vmcnt(0)
L_tapoll:
  ds_read_b32 v16, v18 offset:368
  s_sub_u32 s79, s79, 1
  s_cbranch_scc1 L_end
  s_waitcnt lgkmcnt(0)
  v_cmp_eq_u32 vcc, -1, v16
  s_nop 1
  s_cbranch_vccnz L_tapoll
  ds_read_b64_tr_b16 v[104:105], v17 offset:8192
  ds_read_b64_tr_b16 v[106:107], v17 offset:8704
  ds_read_b64_tr_b16 v[108:109], v17 offset:8224
  ds_read_b64_tr_b16 v[110:111], v17 offset:8736
  ds_read_b64_tr_b16 v[112:113], v17 offset:8256
  ds_read_b64_tr_b16 v[114:115], v17 offset:8768
  ds_read_b64_tr_b16 v[116:117], v17 offset:8288
  ds_read_b64_tr_b16 v[118:119], v17 offset:8800
  ds_read_b64_tr_b16 v[120:121], v17 offset:12288
  ds_read_b64_tr_b16 v[122:123], v17 offset:12800
  ds_read_b64_tr_b16 v[124:125], v17 offset:12320
  ds_read_b64_tr_b16 v[126:127], v17 offset:12832
  ds_read_b64_tr_b16 v[128:129], v17 offset:12352
  ds_read_b64_tr_b16 v[130:131], v17 offset:12864
  s_waitcnt lgkmcnt(12)
  ds_read_b64_tr_b16 v[132:133], v17 offset:12384
  ds_read_b64_tr_b16 v[134:135], v17 offset:12896
  s_waitcnt lgkmcnt(8)
  v_mfma_f32_16x16x32_bf16 v[20:23], v[104:107], v[36:39], 0
  v_mfma_f32_16x16x32_bf16 v[24:27], v[108:111], v[36:39], 0
  v_mfma_f32_16x16x32_bf16 v[28:31], v[112:115], v[36:39], 0
  v_mfma_f32_16x16x32_bf16 v[32:35], v[116:119], v[36:39], 0
  ds_read_b64_tr_b16 v[136:137], v17 offset:16384
  ds_read_b64_tr_b16 v[138:139], v17 offset:16896
  ds_read_b64_tr_b16 v[140:141], v17 offset:16416
  ds_read_b64_tr_b16 v[142:143], v17 offset:16928
  ds_read_b64_tr_b16 v[144:145], v17 offset:16448
  ds_read_b64_tr_b16 v[146:147], v17 offset:16960
  s_waitcnt lgkmcnt(12)
  ds_read_b64_tr_b16 v[148:149], v17 offset:16480
  ds_read_b64_tr_b16 v[150:151], v17 offset:16992
  s_waitcnt lgkmcnt(8)
  v_mfma_f32_16x16x32_bf16 v[20:23], v[120:123], v[40:43], v[20:23]
  v_mfma_f32_16x16x32_bf16 v[24:27], v[124:127], v[40:43], v[24:27]
  v_mfma_f32_16x16x32_bf16 v[28:31], v[128:131], v[40:43], v[28:31]
  v_mfma_f32_16x16x32_bf16 v[32:35], v[132:135], v[40:43], v[32:35]
  ds_read_b64_tr_b16 v[152:153], v17 offset:20480
  ds_read_b64_tr_b16 v[154:155], v17 offset:20992
  ds_read_b64_tr_b16 v[156:157], v17 offset:20512
  ds_read_b64_tr_b16 v[158:159], v17 offset:21024
  ds_read_b64_tr_b16 v[160:161], v17 offset:20544
  ds_read_b64_tr_b16 v[162:163], v17 offset:21056
  s_waitcnt lgkmcnt(12)
  ds_read_b64_tr_b16 v[164:165], v17 offset:20576
  ds_read_b64_tr_b16 v[166:167], v17 offset:21088
  s_waitcnt lgkmcnt(8)
  v_mfma_f32_16x16x32_bf16 v[20:23], v[136:139], v[44:47], v[20:23]
  v_mfma_f32_16x16x32_bf16 v[24:27], v[140:143], v[44:47], v[24:27]
  v_mfma_f32_16x16x32_bf16 v[28:31], v[144:147], v[44:47], v[28:31]
  v_mfma_f32_16x16x32_bf16 v[32:35], v[148:151], v[44:47], v[32:35]
  s_waitcnt lgkmcnt(0)
  v_mfma_f32_16x16x32_bf16 v[20:23], v[152:155], v[48:51], v[20:23]
  v_mfma_f32_16x16x32_bf16 v[24:27], v[156:159], v[48:51], v[24:27]
  v_mfma_f32_16x16x32_bf16 v[28:31], v[160:163], v[48:51], v[28:31]
  v_mfma_f32_16x16x32_bf16 v[32:35], v[164:167], v[48:51], v[32:35]
L_slpoll:
  ds_read_b32 v16, v11 offset:320
  s_sub_u32 s79, s79, 1
  s_cbranch_scc1 L_end
  s_waitcnt lgkmcnt(0)
  v_cmp_eq_u32 vcc, -1, v16
  s_nop 1
  s_cbranch_vccnz L_slpoll
  v_readfirstlane_b32 s82, v16
  v_cmp_gt_u32 vcc, 8, v13
  s_nop 1
  v_cndmask_b32 v52, v24, v20, vcc
  v_cndmask_b32 v53, v25, v21, vcc
  v_cndmask_b32 v54, v26, v22, vcc
  v_cndmask_b32 v55, v27, v23, vcc
  v_cndmask_b32 v56, v32, v28, vcc
  v_cndmask_b32 v57, v33, v29, vcc
  v_cndmask_b32 v58, v34, v30, vcc
  v_cndmask_b32 v59, v35, v31, vcc
  v_or_b32 v52, 1, v52
  v_or_b32 v53, 1, v53
  v_or_b32 v54, 1, v54
  v_or_b32 v55, 1, v55
  v_or_b32 v56, 1, v56
  v_or_b32 v57, 1, v57
  v_or_b32 v58, 1, v58
  v_or_b32 v59, 1, v59
  s_lshl_b32 s75, s77, 11
  s_add_u32 s74, s78, s75
  s_cmp_lg_u32 s82, 0
  s_cbranch_scc1 L_pubp_wt
  buffer_store_dwordx4 v[52:55], v10, s[60:63], s74 offen offset:0
  buffer_store_dwordx4 v[56:59], v10, s[60:63], s74 offen offset:128
  s_branch L_pubp_done
L_pubp_wt:
  buffer_store_dwordx4 v[52:55], v10, s[60:63], s74 offen offset:0 sc1
  buffer_store_dwordx4 v[56:59], v10, s[60:63], s74 offen offset:128 sc1
L_pubp_done:
  v_lshrrev_b32 v16, 5, v0
  v_lshlrev_b32 v16, 14, v16
  v_and_b32 v17, 31, v0
  v_lshl_or_b32 v16, v17, 3, v16
  s_mul_i32 s76, s31, 16128
  s_sub_u32 s74, s74, s76
  s_add_u32 s70, s70, s75
  s_add_u32 s76, s71, s75
  v_lshlrev_b32 v17, 3, v15
  s_waitcnt vmcnt(0)
  s_mov_b64 exec, 1
  s_cmp_lg_u32 s82, 0
  s_cbranch_scc1 L_flgp_wt
  buffer_store_dwordx2 v[102:103], v11, s[60:63], s70 offen offset:2048
  s_branch L_flgp_done
L_flgp_wt:
  buffer_store_dwordx2 v[102:103], v11, s[60:63], s70 offen offset:2048 sc1
L_flgp_done:
  s_mov_b64 exec, -1
L_ppoll:
  buffer_load_dwordx2 v[20:21], v17, s[60:63], s76 offen offset:2048 sc1
  s_sub_u32 s79, s79, 1
  s_cbranch_scc1 L_end
  s_waitcnt vmcnt(0)
  v_cmp_ne_u64 vcc, s[84:85], v[20:21]
  s_nop 1
  s_cbranch_vccnz L_ppoll
  buffer_load_dwordx2 v[20:21], v16, s[60:63], s74 offen sc1
  s_add_u32 s74, s74, 0x8000
  buffer_load_dwordx2 v[24:25], v16, s[60:63], s74 offen sc1
  s_add_u32 s74, s74, 0x8000
  buffer_load_dwordx2 v[28:29], v16, s[60:63], s74 offen sc1
  s_add_u32 s74, s74, 0x8000
  buffer_load_dwordx2 v[32:33], v16, s[60:63], s74 offen sc1
  s_waitcnt vmcnt(0)
  v_pk_add_f32 v[20:21], v[20:21], v[24:25]
  v_pk_add_f32 v[28:29], v[28:29], v[32:33]
  v_pk_add_f32 v[20:21], v[20:21], v[28:29]
  v_cvt_pk_bf16_f32 v20, v20, v21
  s_cmp_lg_u32 s77, 0
  s_cbranch_scc1 L_ffn
  v_lshlrev_b32 v14, 2, v0
  v_min_u32 v20, -2, v20
  ds_write_b32 v14, v20 offset:0
  s_branch L_tail
L_ffn:
  v_mov_b32 v21, v20
  s_nop 1
  v_permlane32_swap_b32 v20, v21
  v_lshlrev_b32 v22, 16, v20
  v_and_b32 v23, 0xffff0000, v20
  v_lshlrev_b32 v24, 16, v21
  v_and_b32 v25, 0xffff0000, v21
  v_mul_f32 v26, 0xbfb8aa3b, v22
  v_exp_f32 v26, v26
  s_nop 0
  v_add_f32 v26, 1.0, v26
  v_rcp_f32 v26, v26
  s_nop 0
  v_mul_f32 v26, v26, v22
  v_cvt_pk_bf16_f32 v26, v26, v26
  v_and_b32 v26, 0xffff0000, v26
  v_mul_f32 v26, v26, v24
  v_mul_f32 v27, 0xbfb8aa3b, v23
  v_exp_f32 v27, v27
  s_nop 0
  v_add_f32 v27, 1.0, v27
  v_rcp_f32 v27, v27
  s_nop 0
  v_mul_f32 v27, v27, v23
  v_cvt_pk_bf16_f32 v27, v27, v27
  v_and_b32 v27, 0xffff0000, v27
  v_mul_f32 v27, v27, v25
  v_cvt_pk_bf16_f32 v52, v26, v27
  v_mov_b32 v54, s84
  v_mov_b32 v55, s85
  v_mov_b32_dpp v53, v52 quad_perm:[1,1,3,3] row_mask:0xf bank_mask:0xf
  v_lshlrev_b32 v14, 3, v0
  s_lshl_b32 s74, s30, 11
  s_lshl_b32 s75, s31, 8
  s_add_u32 s74, s74, s75
  s_add_u32 s74, s74, 0x10000
  s_mov_b32 exec_lo, 0x55555555
  s_mov_b32 exec_hi, 0
  buffer_store_dwordx4 v[52:55], v14, s[60:63], s74 offen sc1
  s_mov_b64 exec, -1
L_qdone:
  ds_read_b32 v16, v11 offset:0
  s_sub_u32 s79, s79, 1
  s_cbranch_scc1 L_end
  s_waitcnt lgkmcnt(0)
  v_cmp_eq_u32 vcc, -1, v16
  s_nop 1
  s_cbranch_vccnz L_qdone
  s_addk_i32 s70, 2048
  s_mov_b64 exec, 1
  s_cmp_lg_u32 s82, 0
  s_cbranch_scc1 L_flgd_wt
  buffer_store_dwordx2 v[102:103], v11, s[60:63], s70 offen offset:2048
  s_branch L_flgd_done
L_flgd_wt:
  buffer_store_dwordx2 v[102:103], v11, s[60:63], s70 offen offset:2048 sc1
L_flgd_done:
  s_mov_b64 exec, -1
  v_bfe_u32 v14, v0, 2, 2
  v_lshlrev_b32 v14, 9, v14
  v_and_b32 v16, 1, v0
  v_lshl_or_b32 v14, v16, 8, v14
  v_lshl_or_b32 v14, v12, 5, v14
  v_and_b32 v16, 2, v0
  v_lshl_or_b32 v14, v16, 3, v14
  v_and_b32 v17, 31, v0
  v_lshlrev_b32 v17, 3, v17
  s_add_u32 s75, s69, 6144
  s_lshl_b32 s74, s91, 11
  s_add_u32 s74, s74, 0x10000
L_mtpoll:
  ds_read_b32 v16, v11 offset:324
  s_sub_u32 s79, s79, 1
  s_cbranch_scc1 L_end
  s_waitcnt lgkmcnt(0)
  v_cmp_eq_u32 vcc, -1, v16
  s_nop 1
  s_cbranch_vccnz L_mtpoll
L_hpoll:
  buffer_load_dwordx2 v[20:21], v17, s[60:63], s75 offen sc1
  buffer_load_dwordx4 v[60:63], v14, s[60:63], s74 offen sc1
  buffer_load_dwordx4 v[64:67], v14, s[60:63], s74 offen offset:128 sc1
  s_sub_u32 s79, s79, 1
  s_cbranch_scc1 L_end
  s_waitcnt vmcnt(0)
  v_cmp_ne_u64 vcc, s[84:85], v[20:21]
  v_cmp_ne_u64 s[88:89], s[84:85], v[62:63]
  s_nop 1
  s_or_b64 s[88:89], s[88:89], vcc
  v_cmp_ne_u64 vcc, s[84:85], v[66:67]
  s_nop 1
  s_or_b64 s[88:89], s[88:89], vcc
  s_cbranch_scc1 L_hpoll
  v_mov_b32_dpp v62, v60 quad_perm:[2,3,0,1] row_mask:0xf bank_mask:0xf
  v_mov_b32_dpp v63, v61 quad_perm:[2,3,0,1] row_mask:0xf bank_mask:0xf
  v_mov_b32_dpp v66, v64 quad_perm:[2,3,0,1] row_mask:0xf bank_mask:0xf
  v_mov_b32_dpp v67, v65 quad_perm:[2,3,0,1] row_mask:0xf bank_mask:0xf
  v_mov_b32 v16, s82
  ds_write_b128 v1, v[60:63] offset:5376
  ds_write_b128 v1, v[64:67] offset:6400
  ds_write_b32 v11, v16 offset:328
  s_branch L_tail
L_wlate:
  s_cmp_lg_u32 s77, 2
  s_cbranch_scc1 L_gate
  v_and_b32 v17, 31, v0
  v_lshlrev_b32 v17, 3, v17
  s_mov_b32 s74, 6
  s_mov_b32 s82, 1
L_hello:
  s_sub_u32 s74, s74, 1
  s_cbranch_scc1 L_hello_done
  buffer_load_dwordx2 v[20:21], v17, s[60:63], s69 offen sc1
  s_waitcnt vmcnt(0)
  v_cmp_ne_u64 vcc, s[86:87], v[20:21]
  s_nop 1
  s_cbranch_vccnz L_hello
  s_mov_b32 s82, 0
L_hello_done:
  v_mov_b32 v16, s82
  ds_write_b32 v11, v16 offset:320
  s_branch L_tail
L_gate:
  s_lshl_b32 s75, s31, 10
  buffer_load_dwordx4 v[36:39], v1, s[44:47], s75 offen
  buffer_load_dwordx4 v[40:43], v1, s[40:43], 0 offen
  s_waitcnt vmcnt(0)
  v_lshlrev_b32 v20, 16, v36
  v_and_b32 v21, 0xffff0000, v36
  v_lshlrev_b32 v28, 16, v40
  v_and_b32 v29, 0xffff0000, v40
  v_lshlrev_b32 v22, 16, v37
  v_and_b32 v23, 0xffff0000, v37
  v_lshlrev_b32 v30, 16, v41
  v_and_b32 v31, 0xffff0000, v41
  v_lshlrev_b32 v24, 16, v38
  v_and_b32 v25, 0xffff0000, v38
  v_lshlrev_b32 v32, 16, v42
  v_and_b32 v33, 0xffff0000, v42
  v_lshlrev_b32 v26, 16, v39
  v_and_b32 v27, 0xffff0000, v39
  v_lshlrev_b32 v34, 16, v43
  v_and_b32 v35, 0xffff0000, v43
  v_mul_f32 v20, v20, v28
  v_mul_f32 v21, v21, v29
  v_mul_f32 v22, v22, v30
  v_mul_f32 v23, v23, v31
  v_mul_f32 v24, v24, v32
  v_mul_f32 v25, v25, v33
  v_mul_f32 v26, v26, v34
  v_mul_f32 v27, v27, v35
  v_cvt_pk_bf16_f32 v20, v20, v20
  v_and_b32 v20, 0xffff0000, v20
  v_cvt_pk_bf16_f32 v21, v21, v21
  v_and_b32 v21, 0xffff0000, v21
  v_cvt_pk_bf16_f32 v22, v22, v22
  v_and_b32 v22, 0xffff0000, v22
  v_cvt_pk_bf16_f32 v23, v23, v23
  v_and_b32 v23, 0xffff0000, v23
  v_cvt_pk_bf16_f32 v24, v24, v24
  v_and_b32 v24, 0xffff0000, v24
  v_cvt_pk_bf16_f32 v25, v25, v25
  v_and_b32 v25, 0xffff0000, v25
  v_cvt_pk_bf16_f32 v26, v26, v26
  v_and_b32 v26, 0xffff0000, v26
  v_cvt_pk_bf16_f32 v27, v27, v27
  v_and_b32 v27, 0xffff0000, v27
  v_pk_add_f32 v[20:21], v[20:21], v[24:25]
  v_pk_add_f32 v[22:23], v[22:23], v[26:27]
  v_pk_add_f32 v[20:21], v[20:21], v[22:23]
  v_add_f32 v20, v20, v21
  s_nop 1
  v_add_f32_dpp v20, v20, v20 quad_perm:[1,0,3,2] row_mask:0xf bank_mask:0xf
  s_nop 1
  v_add_f32_dpp v20, v20, v20 quad_perm:[2,3,0,1] row_mask:0xf bank_mask:0xf
  s_nop 1
  v_add_f32_dpp v20, v20, v20 row_ror:4 row_mask:0xf bank_mask:0xf
  s_nop 1
  v_add_f32_dpp v20, v20, v20 row_ror:8 row_mask:0xf bank_mask:0xf
  v_mov_b32 v14, v20
  s_nop 1
  v_permlane16_swap_b32 v20, v14
  v_add_f32 v20, v20, v14
  v_mov_b32 v14, v20
  s_nop 1
  v_permlane32_swap_b32 v20, v14
  v_add_f32 v20, v20, v14
  v_cvt_pk_bf16_f32 v20, v20, v20
  v_and_b32 v20, 0xffff0000, v20
  v_mul_f32 v22, 0xbfb8aa3b, v20
  v_exp_f32 v22, v22
  s_nop 0
  v_add_f32 v22, 1.0, v22
  v_rcp_f32 v22, v22
  s_nop 0
  v_cvt_pk_bf16_f32 v22, v22, v22
  v_and_b32 v22, 0xffff0000, v22
  v_sub_f32 v23, 1.0, v22
  v_cvt_pk_bf16_f32 v23, v23, v23
  v_and_b32 v23, 0xffff0000, v23
  v_and_b32 v14, 16, v0
  v_cmp_eq_u32 vcc, 0, v14
  s_nop 1
  v_cndmask_b32 v96, v23, v22, vcc
L_tail:
  v_lshrrev_b32 v14, 3, v0
  v_lshlrev_b32 v16, 4, v15
  v_lshl_or_b32 v8, v14, 10, v16
  v_lshl_or_b32 v100, v14, 12, v16
  v_lshrrev_b32 v14, 5, v0
  v_lshlrev_b32 v101, 1, v15
  v_lshl_or_b32 v101, v14, 4, v101
  v_lshlrev_b32 v99, 3, v0
  v_lshl_add_u32 v99, v14, 4, v99
  s_mul_i32 s75, s77, 544
  v_add_u32 v99, s75, v99
  v_bfe_u32 v14, v0, 2, 2
  v_and_b32 v16, 1, v0
  v_lshl_or_b32 v14, v14, 1, v16
  v_mul_u32_u24 v98, 272, v14
  v_lshl_add_u32 v98, v12, 4, v98
  v_mov_b32 v97, -2
  s_lshl_b32 s75, s77, 5
  v_add_u32 v9, s75, v9
  v_and_b32 v17, 12, v0
  s_lshl_b32 s75, s77, 2
  v_mov_b32 v18, s75
L_hwpoll:
  ds_read_b32 v16, v11 offset:328
  s_sub_u32 s79, s79, 1
  s_cbranch_scc1 L_end
  s_waitcnt lgkmcnt(0)
  v_cmp_eq_u32 vcc, -1, v16
  s_nop 1
  s_cbranch_vccnz L_hwpoll
  ds_read_b128 v[60:63], v1 offset:5376
  ds_read_b128 v[64:67], v1 offset:6400
  v_readfirstlane_b32 s82, v16
  s_and_b32 s74, s91, 7
  s_xor_b32 s74, s74, s90
  s_or_b32 s74, s74, s82
  s_mov_b32 s70, 0x40000
  s_cmp_lg_u32 s74, 0
  s_cselect_b32 s70, 0x20000, s70
  s_lshl_b32 s74, s91, 12
  s_add_u32 s70, s70, s74
  s_lshl_b32 s74, s77, 10
  s_add_u32 s70, s70, s74
  s_add_u32 s78, s78, s74
  s_lshl_b32 s71, s90, 17
  s_and_b32 s74, s91, 3
  s_lshl_b32 s75, s74, 10
  s_add_u32 s71, s71, s75
  s_lshl_b32 s75, s31, 7
  s_add_u32 s71, s71, s75
  s_add_u32 s71, s71, 0x100000
  s_add_u32 s72, s71, 0x8000
  s_add_u32 s73, s71, 0x10000
  s_add_u32 s80, s71, 0x18000
  s_lshl_b32 s74, s74, 5
  s_lshl_b32 s75, s90, 7
  s_add_u32 s74, s74, s75
  s_lshl_b32 s75, s31, 10
  s_add_u32 s81, s74, s75
  s_lshl_b32 s74, s77, 14
  s_lshl_b32 s75, s77, 15
  s_lshl_b32 s76, s77, 11
  s_add_u32 m0, s76, 8192
  s_lshl_b32 s76, s77, 12
  s_add_u32 s76, s76, 16384
L_l2poll:
  ds_read_b32 v16, v17 offset:336
  s_sub_u32 s79, s79, 1
  s_cbranch_scc1 L_end
  s_waitcnt lgkmcnt(0)
  v_cmp_eq_u32 vcc, -1, v16
  s_nop 1
  s_cbranch_vccnz L_l2poll
  buffer_load_dwordx4 v8, s[56:59], s74 offen nt lds
  s_addk_i32 m0, 1024
  s_addk_i32 s74, 0x2000
  buffer_load_dwordx4 v8, s[56:59], s74 offen nt lds
  s_mov_b32 m0, s76
  s_nop 0
  buffer_load_dwordx4 v8, s[52:55], s75 offen nt lds
  s_addk_i32 m0, 1024
  s_addk_i32 s75, 0x2000
  buffer_load_dwordx4 v8, s[52:55], s75 offen nt lds
  s_addk_i32 m0, 1024
  s_addk_i32 s75, 0x2000
  buffer_load_dwordx4 v8, s[52:55], s75 offen nt lds
  s_addk_i32 m0, 1024
  s_addk_i32 s75, 0x2000
  buffer_load_dwordx4 v8, s[52:55], s75 offen nt lds
  buffer_load_dwordx4 v[52:55], v1, s[60:63], s70 offen sc1
  s_waitcnt vmcnt(1)
  ds_write_b32 v18, v11 offset:352
  buffer_load_dwordx4 v[104:107], v1, s[60:63], s70 offen sc1
  s_waitcnt vmcnt(1)
  v_cmp_ne_u64 vcc, s[84:85], v[54:55]
  v_min_u32 v56, -2, v52
  v_min_u32 v57, -2, v53
  s_cbranch_vccnz L_olate
  ds_write_b64 v99, v[56:57] offset:3072
L_tfpoll0:
  ds_read_b32 v16, v17 offset:352
  s_sub_u32 s79, s79, 1
  s_cbranch_scc1 L_end
  s_waitcnt lgkmcnt(0)
  v_cmp_eq_u32 vcc, -1, v16
  s_nop 1
  s_cbranch_vccnz L_tfpoll0
  ds_read_b64_tr_b16 v[88:89], v9 offset:8192
  ds_read_b64_tr_b16 v[90:91], v9 offset:8704
  ds_read_b64_tr_b16 v[92:93], v9 offset:12288
  ds_read_b64_tr_b16 v[94:95], v9 offset:12800
  ds_read_b64_tr_b16 v[72:73], v9 offset:16384
  ds_read_b64_tr_b16 v[74:75], v9 offset:16896
  ds_read_b64_tr_b16 v[76:77], v9 offset:20480
  ds_read_b64_tr_b16 v[78:79], v9 offset:20992
  ds_read_b64_tr_b16 v[80:81], v9 offset:24576
  ds_read_b64_tr_b16 v[82:83], v9 offset:25088
  ds_read_b64_tr_b16 v[84:85], v9 offset:28672
  ds_read_b64_tr_b16 v[86:87], v9 offset:29184
  s_waitcnt lgkmcnt(8)
  ds_read_b128 v[48:51], v98 offset:3264
  ds_read_b128 v[36:39], v98 offset:3072
  ds_read_b128 v[40:43], v98 offset:3136
  ds_read_b128 v[44:47], v98 offset:3200
  v_mfma_f32_16x16x32_bf16 v[24:27], v[60:63], v[88:91], 0
  v_mfma_f32_16x16x32_bf16 v[24:27], v[64:67], v[92:95], v[24:27]
  s_branch L_omchk
L_olate:
  buffer_load_dwordx4 v[52:55], v1, s[60:63], s70 offen sc1
L_tfpoll1:
  ds_read_b32 v16, v17 offset:352
  s_sub_u32 s79, s79, 1
  s_cbranch_scc1 L_end
  s_waitcnt lgkmcnt(0)
  v_cmp_eq_u32 vcc, -1, v16
  s_nop 1
  s_cbranch_vccnz L_tfpoll1
  ds_read_b64_tr_b16 v[88:89], v9 offset:8192
  ds_read_b64_tr_b16 v[90:91], v9 offset:8704
  ds_read_b64_tr_b16 v[92:93], v9 offset:12288
  ds_read_b64_tr_b16 v[94:95], v9 offset:12800
  ds_read_b64_tr_b16 v[72:73], v9 offset:16384
  ds_read_b64_tr_b16 v[74:75], v9 offset:16896
  ds_read_b64_tr_b16 v[76:77], v9 offset:20480
  ds_read_b64_tr_b16 v[78:79], v9 offset:20992
  ds_read_b64_tr_b16 v[80:81], v9 offset:24576
  ds_read_b64_tr_b16 v[82:83], v9 offset:25088
  ds_read_b64_tr_b16 v[84:85], v9 offset:28672
  ds_read_b64_tr_b16 v[86:87], v9 offset:29184
  s_waitcnt lgkmcnt(8)
  v_mfma_f32_16x16x32_bf16 v[24:27], v[60:63], v[88:91], 0
  v_mfma_f32_16x16x32_bf16 v[24:27], v[64:67], v[92:95], v[24:27]
L_opoll:
  s_waitcnt vmcnt(1)
  v_cmp_ne_u64 vcc, s[84:85], v[106:107]
  v_min_u32 v56, -2, v104
  v_min_u32 v57, -2, v105
  s_cbranch_vccz L_ogot
  buffer_load_dwordx4 v[104:107], v1, s[60:63], s70 offen sc1
  s_waitcnt vmcnt(1)
  v_cmp_ne_u64 vcc, s[84:85], v[54:55]
  v_min_u32 v56, -2, v52
  v_min_u32 v57, -2, v53
  s_cbranch_vccz L_ogot
  buffer_load_dwordx4 v[52:55], v1, s[60:63], s70 offen sc1
  s_sub_u32 s79, s79, 1
  s_cbranch_scc1 L_end
  s_branch L_opoll
L_ogot:
  ds_write_b64 v99, v[56:57] offset:3072
L_ompoll:
  ds_read_b128 v[48:51], v98 offset:3264
  ds_read_b128 v[36:39], v98 offset:3072
  ds_read_b128 v[40:43], v98 offset:3136
  ds_read_b128 v[44:47], v98 offset:3200
  s_sub_u32 s79, s79, 1
  s_cbranch_scc1 L_end
L_omchk:
  s_waitcnt lgkmcnt(3)
  v_cmp_eq_u32 vcc, -1, v51
  s_nop 1
  s_cbranch_vccnz L_ompoll
  v_mfma_f32_16x16x32_bf16 v[20:23], v[48:51], v[84:87], 0
  v_max3_u32 v14, v48, v49, v50
  s_waitcnt lgkmcnt(2)
  v_mfma_f32_16x16x32_bf16 v[20:23], v[36:39], v[72:75], v[20:23]
  v_and_b32 v70, v24, v97
  v_and_b32 v71, v25, v97
  s_nop 0
  v_and_b32_dpp v70, v25, v97 row_ror:8 row_mask:0xf bank_mask:0xc
  v_and_b32_dpp v71, v24, v97 row_ror:8 row_mask:0xf bank_mask:0x3
  s_waitcnt lgkmcnt(1)
  v_mfma_f32_16x16x32_bf16 v[20:23], v[40:43], v[76:79], v[20:23]
  v_max3_u32 v16, v36, v37, v38
  v_max3_u32 v14, v14, v39, v40
  v_max3_u32 v16, v16, v41, v42
  s_waitcnt lgkmcnt(0)
  v_mfma_f32_16x16x32_bf16 v[20:23], v[44:47], v[80:83], v[20:23]
  v_max3_u32 v14, v14, v43, v44
  v_max3_u32 v16, v16, v45, v46
  v_max3_u32 v14, v14, v16, v47
  v_cmp_eq_u32 vcc, -1, v14
  s_nop 1
  s_cbranch_vccnz L_ompoll
  s_nop 0
  v_and_b32 v68, v20, v97
  v_and_b32 v69, v21, v97
  s_nop 0
  v_and_b32_dpp v68, v21, v97 row_ror:8 row_mask:0xf bank_mask:0xc
  v_and_b32_dpp v69, v20, v97 row_ror:8 row_mask:0xf bank_mask:0x3
  s_cmp_lg_u32 s82, 0
  s_cbranch_scc1 L_puba_wt
  buffer_store_dwordx4 v[68:71], v1, s[60:63], s78 offen
  s_branch L_puba_done
L_puba_wt:
  buffer_store_dwordx4 v[68:71], v1, s[60:63], s78 offen sc1
L_puba_done:
  s_cmp_lg_u32 s77, 3
  s_cbranch_scc1 L_end
  buffer_load_dwordx4 v[120:123], v100, s[60:63], s71 offen sc1
  buffer_load_dwordx4 v[124:127], v100, s[60:63], s72 offen sc1
  buffer_load_dwordx4 v[128:131], v100, s[60:63], s73 offen sc1
  buffer_load_dwordx4 v[132:135], v100, s[60:63], s80 offen sc1
  buffer_load_dwordx4 v[136:139], v100, s[60:63], s71 offen sc1
  buffer_load_dwordx4 v[140:143], v100, s[60:63], s72 offen sc1
  buffer_load_dwordx4 v[144:147], v100, s[60:63], s73 offen sc1
  buffer_load_dwordx4 v[148:151], v100, s[60:63], s80 offen sc1
L_fpoll:
  s_waitcnt vmcnt(4)
  v_or3_b32 v14, v120, v121, v122
  v_or3_b32 v16, v123, v124, v125
  v_or3_b32 v14, v14, v126, v127
  v_or3_b32 v16, v16, v128, v129
  v_or3_b32 v14, v14, v130, v131
  v_or3_b32 v16, v16, v132, v133
  v_or3_b32 v14, v14, v134, v135
  v_or_b32 v14, v14, v16
  v_and_b32 v14, 1, v14
  v_cmp_ne_u32 vcc, 0, v14
  v_pk_add_f32 v[36:37], v[120:121], v[124:125]
  v_pk_add_f32 v[38:39], v[122:123], v[126:127]
  v_pk_add_f32 v[44:45], v[128:129], v[132:133]
  v_pk_add_f32 v[46:47], v[130:131], v[134:135]
  s_cbranch_vccz L_fgot
  buffer_load_dwordx4 v[120:123], v100, s[60:63], s71 offen sc1
  buffer_load_dwordx4 v[124:127], v100, s[60:63], s72 offen sc1
  buffer_load_dwordx4 v[128:131], v100, s[60:63], s73 offen sc1
  buffer_load_dwordx4 v[132:135], v100, s[60:63], s80 offen sc1
  s_waitcnt vmcnt(4)
  v_or3_b32 v14, v136, v137, v138
  v_or3_b32 v16, v139, v140, v141
  v_or3_b32 v14, v14, v142, v143
  v_or3_b32 v16, v16, v144, v145
  v_or3_b32 v14, v14, v146, v147
  v_or3_b32 v16, v16, v148, v149
  v_or3_b32 v14, v14, v150, v151
  v_or_b32 v14, v14, v16
  v_and_b32 v14, 1, v14
  v_cmp_ne_u32 vcc, 0, v14
  v_pk_add_f32 v[36:37], v[136:137], v[140:141]
  v_pk_add_f32 v[38:39], v[138:139], v[142:143]
  v_pk_add_f32 v[44:45], v[144:145], v[148:149]
  v_pk_add_f32 v[46:47], v[146:147], v[150:151]
  s_cbranch_vccz L_fgot
  buffer_load_dwordx4 v[136:139], v100, s[60:63], s71 offen sc1
  buffer_load_dwordx4 v[140:143], v100, s[60:63], s72 offen sc1
  buffer_load_dwordx4 v[144:147], v100, s[60:63], s73 offen sc1
  buffer_load_dwordx4 v[148:151], v100, s[60:63], s80 offen sc1
  s_sub_u32 s79, s79, 1
  s_cbranch_scc1 L_end
  s_branch L_fpoll
L_fgot:
  v_pk_add_f32 v[36:37], v[36:37], v[44:45]
  v_pk_add_f32 v[38:39], v[38:39], v[46:47]
  s_nop 0
  v_permlane32_swap_b32 v36, v37
  v_permlane32_swap_b32 v38, v39
  v_add_f32 v36, v36, v37
  v_add_f32 v38, v38, v39
  s_nop 1
  v_permlane16_swap_b32 v36, v38
  v_add_f32 v36, v36, v38
  s_nop 1
  v_add_f32_dpp v36, v36, v36 row_ror:8 row_mask:0xf bank_mask:0xf
  v_cvt_pk_bf16_f32 v36, v36, v36
  v_and_b32 v36, 0xffff0000, v36
  v_mul_f32 v36, v36, v96
  v_cvt_pk_bf16_f32 v37, v36, v36
  v_and_b32 v36, 0xffff0000, v37
  v_and_b32 v37, 0xffff0000, v37
  s_nop 1
  v_permlane16_swap_b32 v36, v37
  v_add_f32 v36, v36, v37
  v_cvt_pk_bf16_f32 v36, v36, v36
  buffer_store_short v36, v101, s[64:67], s81 offen
  s_cmp_lg_u32 s2, 0
  s_cbranch_scc1 L_end
  s_mov_b64 exec, 1
  buffer_store_dwordx2 v[102:103], v11, s[60:63], 0 offen offset:0
L_end:
  s_endpgm
L_last:
.section .rodata,"a"
.p2align 6
.amdhsa_kernel gated_mix__sliding_block_cached__glu_gated_swiglu__decode_kernel
  .amdhsa_next_free_vgpr 256
  .amdhsa_next_free_sgpr 102
  .amdhsa_accum_offset 256
  .amdhsa_group_segment_fixed_size 0
  .amdhsa_kernarg_size 104
  .amdhsa_user_sgpr_count 2
  .amdhsa_user_sgpr_kernarg_segment_ptr 1
  .amdhsa_system_sgpr_workgroup_id_x 1
  .amdhsa_float_denorm_mode_32 3
.end_amdhsa_kernel
```
